```python
import torch

def _softmax(x, axis=-1):
    return torch.softmax(x, dim=axis)
def _gelu(x):
    return torch.nn.functional.gelu(x, approximate="tanh")
def _silu(x):
    return torch.nn.functional.silu(x)
def _sigmoid(x):
    return torch.sigmoid(x)
def _layernorm(x, axis=-1, eps=1e-5):
    m = x.mean(dim=axis, keepdim=True)
    v = x.var(dim=axis, keepdim=True, unbiased=False)
    return (x - m) / torch.sqrt(v + eps)
def _scatter_add(tgt, idx, src, axis=0):
    return tgt.clone().index_add_(axis, idx, src)
def _segment_sum(src, seg, n):
    out = torch.zeros((n,) + src.shape[1:], dtype=src.dtype)
    return out.index_add_(0, seg, src)
def _pad(x, pw):
    flat = tuple(v for pair in reversed(pw) for v in pair)
    return torch.nn.functional.pad(x, flat)

kernel_name = 'recurrent_scan__softmax_full_mha__moe_arch_mod__prompt'

def setup_inputs():

    _w = (lambda a: (lambda t: t.to(torch.bfloat16) if t.is_floating_point() else t)(torch.as_tensor(a)))
    def _A_setup():
        B, S, D = 1, 2048, 512
        return {
            "x": _w((lambda *s: torch.randn(*s, dtype=torch.bfloat16) * 0.05)(B, S, D)),
            "wqkv": _w((lambda *s: torch.randn(*s, dtype=torch.bfloat16) * 0.05)(D, 3 * D)),
            "wo": _w((lambda *s: torch.randn(*s, dtype=torch.bfloat16) * 0.05)(D, D)),
        }
    _A_in = _A_setup()

    def _B_setup():
        B, S, D, F, C = 1, 2048, 512, 1792, 2
        return {
            "x": _w((lambda *s: torch.randn(*s, dtype=torch.bfloat16) * 0.05)(B, S, D)),
            "w_r": _w((lambda *s: torch.randn(*s, dtype=torch.bfloat16) * 0.05)(D)),
            "w_gate": _w((lambda *s: torch.randn(*s, dtype=torch.bfloat16) * 0.05)(D, F)),
            "w_up": _w((lambda *s: torch.randn(*s, dtype=torch.bfloat16) * 0.05)(D, F)),
            "w_down": _w((lambda *s: torch.randn(*s, dtype=torch.bfloat16) * 0.05)(F, D)),
        }
    _B_in = _B_setup()

    return {
        "A_x": _A_in["x"],
        "A_wqkv": _A_in["wqkv"],
        "A_wo": _A_in["wo"],
        "B_x": _B_in["x"],
        "B_w_r": _B_in["w_r"],
        "B_w_gate": _B_in["w_gate"],
        "B_w_up": _B_in["w_up"],
        "B_w_down": _B_in["w_down"],
    }

def reference(A_x, A_wqkv, A_wo, B_x, B_w_r, B_w_gate, B_w_up, B_w_down):
    def _A_ref(x, wqkv, wo):
        B, S, D = x.shape
        H = 32; Dh = D // H
        qkv = (lambda x, *d: x.permute(*d))((x @ wqkv).reshape(B, S, 3, H, Dh), 2, 0, 3, 1, 4)
        q, k, v = qkv[0], qkv[1], qkv[2]
        scale = Dh ** -0.5
        scores = torch.einsum("bhqd,bhkd->bhqk", q, k) * scale
        p = _softmax(scores, axis=-1)
        o = torch.einsum("bhqk,bhkd->bhqd", p, v)
        return (lambda x, *d: x.permute(*d))(o, 0, 2, 1, 3).reshape(B, S, D) @ wo

    def _B_ref(x, w_r, w_gate, w_up, w_down):
        B, S, D = x.shape
        C = 2
        r = x @ w_r
        idx = torch.argsort(-r, axis=-1)[:, :C]
        idx_e = (lambda x, n, axis: torch.repeat_interleave(x, n, dim=axis))(idx.reshape(B, C, 1), D, axis=2)
        x_sel = (lambda x, i, axis: torch.take_along_dim(x, i, dim=axis))(x, idx_e, axis=1)
        g = _silu(x_sel @ w_gate)
        u = x_sel @ w_up
        y = (g * u) @ w_down
        r_sel = _sigmoid((lambda x, i, axis: torch.take_along_dim(x, i, dim=axis))(r, idx, axis=1))
        y = y * r_sel.reshape(B, C, 1)
        b_off = (torch.arange(B) * S).reshape(B, 1)
        flat_idx = (idx + b_off).reshape(B * C)
        zero = (x * 0.0).reshape(B * S, D)
        upd = _scatter_add(zero, flat_idx, y.reshape(B * C, D), axis=0)
        return x + upd.reshape(B, S, D)

    x = A_x
    xn = _layernorm(x, axis=-1)
    s = _A_ref(xn, A_wqkv, A_wo)
    g = _silu(_B_ref(xn, B_w_r, B_w_gate, B_w_up, B_w_down))
    return x + s * g
```

```asm
; @launch grid=(256,1,1) block=(768,1,1) lds=163840
.amdgcn_target "amdgcn-amd-amdhsa--gfx950"
.text
.globl recurrent_scan__softmax_full_mha__moe_arch_mod__prompt_kernel
.p2align 12
.p2align 8
.type recurrent_scan__softmax_full_mha__moe_arch_mod__prompt_kernel,@function
recurrent_scan__softmax_full_mha__moe_arch_mod__prompt_kernel:
    s_cmp_ge_u32 s2, 256
    s_cbranch_scc1 L_exit
    s_load_dwordx16 s[8:23], s[0:1], 0
    s_load_dwordx4 s[24:27], s[0:1], 64
    s_load_dwordx2 s[28:29], s[0:1], 80
    v_lshrrev_b32 v1, 6, v0
    v_and_b32 v0, 63, v0
    s_lshr_b32 s3, s2, 4
    v_readfirstlane_b32 s5, v1
    s_and_b32 s4, s2, 7
    s_lshl_b32 s4, s4, 1
    s_bfe_u32 s30, s2, 0x10003
    s_or_b32 s4, s4, s30
    s_lshl_b32 s7, s30, 2
    s_lshl_b32 s30, s3, 2
    s_lshr_b32 s30, 0x30630630, s30
    s_add_u32 s7, s7, s30
    s_lshl_b32 s30, s2, 2
    s_lshr_b32 s30, 0x22002200, s30
    s_add_u32 s7, s7, s30
    s_and_b32 s7, s7, 7
    s_and_b32 s6, s5, 3
    s_mov_b32 s48, 0x3f803f80
    s_cmp_lt_u32 s5, 4
    s_cbranch_scc1 L_helper
    s_cmp_lg_u32 s5, 8
    s_cbranch_scc1 L_compute
    s_getpc_b64 s[50:51]
L_pc:
    s_lshr_b32 s30, s2, 3
    s_lshl_b32 s30, s30, 10
    v_lshl_add_u32 v1, v0, 7, s30
    v_min_u32 v1, L_exit-L_pc, v1
    v_mov_b32 v7, s51
    v_add_co_u32 v6, vcc, s50, v1
    s_nop 1
    v_addc_co_u32 v7, vcc, 0, v7, vcc
    s_mov_b64 exec, 0xff
    global_load_dword v136, v[6:7], off
    s_mov_b64 exec, -1
    s_branch L_compute
L_clear:
    v_lshlrev_b32 v7, 7, v0
    v_lshlrev_b32 v8, 4, v0
    v_mov_b32 v9, 1
    v_mov_b64 v[24:25], 0
    v_mov_b64 v[26:27], 0
    s_mov_b32 s30, 6291456
    s_mov_b32 s31, 6299648
    buffer_store_dword v24, v7, s[40:43], s30 offen sc1
    buffer_store_dwordx4 v[24:27], v8, s[40:43], s31 offen offset:0 sc1
    buffer_store_dwordx4 v[24:27], v8, s[40:43], s31 offen offset:1024 sc1
    buffer_store_dwordx4 v[24:27], v8, s[40:43], s31 offen offset:2048 sc1
    buffer_store_dwordx4 v[24:27], v8, s[40:43], s31 offen offset:3072 sc1
    s_add_u32 s31, s31, 4096
    buffer_store_dwordx4 v[24:27], v8, s[40:43], s31 offen offset:0 sc1
    buffer_store_dwordx4 v[24:27], v8, s[40:43], s31 offen offset:1024 sc1
    buffer_store_dwordx4 v[24:27], v8, s[40:43], s31 offen offset:2048 sc1
    buffer_store_dwordx4 v[24:27], v8, s[40:43], s31 offen offset:3072 sc1
    s_add_u32 s31, s31, 4096
    buffer_store_dwordx4 v[24:27], v8, s[40:43], s31 offen offset:0 sc1
    buffer_store_dwordx4 v[24:27], v8, s[40:43], s31 offen offset:1024 sc1
    s_mov_b32 s30, 6309888
    buffer_store_dword v24, v7, s[40:43], s30 offen sc1
    s_branch L_cleared
L_helper:
    v_lshrrev_b32 v1, 2, v0
    s_lshl_b32 s30, s6, 4
    v_add_u32 v1, s30, v1
    v_mul_u32_u24 v1, 3072, v1
    v_and_b32 v2, 3, v0
    v_lshl_add_u32 v1, v2, 4, v1
    s_lshl_b32 s30, s3, 6
    v_add_u32 v14, s30, v1
    s_and_b32 s31, s3, 1
    s_lshl_b32 s31, 1024, s31
    s_andn2_b32 s30, s30, 64
    s_add_u32 s30, s30, s31
    s_mul_i32 s31, s6, 49152
    s_add_u32 s30, s30, s31
    v_lshrrev_b32 v1, 3, v0
    v_lshrrev_b32 v2, 4, v0
    v_and_b32 v3, 7, v0
    v_and_b32 v4, 2, v1
    v_xor_b32 v4, v3, v4
    v_xor_b32 v5, 4, v4
    v_mul_u32_u24 v6, 3072, v1
    v_add_u32 v6, s30, v6
    v_lshl_add_u32 v15, v4, 4, v6
    v_lshl_add_u32 v16, v5, 4, v6
    v_add_u32 v16, 23552, v16
    v_xor_b32 v4, v3, v2
    v_xor_b32 v5, 4, v4
    s_lshl_b32 s30, s4, 17
    s_lshl_b32 s31, s6, 15
    s_add_u32 s30, s30, s31
    v_lshl_add_u32 v6, v1, 10, s30
    v_lshl_add_u32 v10, v4, 4, v6
    v_lshl_add_u32 v11, v5, 4, v6
    v_add_u32 v12, 14336, v10
    v_add_u32 v13, 21504, v11
    v_add_u32 v11, 7168, v11
    v_add_u32 v1, s7, v1
    v_and_b32 v1, 7, v1
    v_lshlrev_b32 v1, 7, v1
    v_lshl_add_u32 v1, v3, 4, v1
    s_lshl_b32 s57, s6, 12
    s_lshl_b32 s49, s6, 10
    s_mov_b32 s34, 2097152
    s_mov_b32 s35, 0x20000
    s_mov_b32 s38, 1572864
    s_mov_b32 s39, 0x20000
    s_mov_b32 s46, 1024
    s_mov_b32 s47, 0x20000
    s_mul_i32 s51, s7, 196608
    s_lshl_b32 s53, s6, 11
    s_mov_b32 m0, s53
    s_mov_b32 s42, 268435456
    s_mov_b32 s43, 0x20000
    s_lshl_b32 s52, s2, 2
    s_add_u32 s52, s52, s6
    s_cmp_eq_u32 s52, 3
    s_waitcnt lgkmcnt(0)
    s_mov_b64 s[36:37], s[10:11]
    s_mov_b64 s[32:33], s[8:9]
    s_mov_b64 s[40:41], s[28:29]
    s_cbranch_scc1 L_clear
L_cleared:
    buffer_load_dwordx4 v15, s[36:39], s51 offen lds
    buffer_load_dwordx4 v16, s[36:39], s51 offen offset:1024 lds
    s_cmp_lg_u32 s6, 0
    s_cbranch_scc1 L_h_nowr
    s_mov_b32 m0, 155648
    s_mov_b64 s[44:45], s[16:17]
    buffer_load_dwordx4 v1, s[44:47], 0 offen lds
L_h_nowr:
    s_add_u32 s50, s7, 0
    s_and_b32 s50, s50, 7
    s_add_u32 m0, s57, 65536
    s_lshl_b32 s50, s50, 7
    buffer_load_dwordx4 v10, s[32:35], s50 offen offset:0 lds
    buffer_load_dwordx4 v11, s[32:35], s50 offen offset:1024 lds
    buffer_load_dwordx4 v12, s[32:35], s50 offen offset:2048 lds
    buffer_load_dwordx4 v13, s[32:35], s50 offen offset:3072 lds
    s_add_u32 s50, s7, 1
    s_and_b32 s50, s50, 7
    s_add_u32 m0, s53, 8192
    s_mul_i32 s51, s50, 196608
    buffer_load_dwordx4 v15, s[36:39], s51 offen lds
    buffer_load_dwordx4 v16, s[36:39], s51 offen offset:1024 lds
    s_cmp_lg_u32 s52, 3
    s_cbranch_scc1 L_h_nosig
    s_mov_b64 s[44:45], s[26:27]
    s_mov_b32 s46, 256
    s_waitcnt vmcnt(8)
    s_mov_b64 exec, 1
    buffer_store_dword v9, v0, s[44:47], 0 offen sc1
    s_mov_b64 exec, -1
L_h_nosig:
    s_add_u32 s50, s7, 1
    s_and_b32 s50, s50, 7
    s_add_u32 m0, s57, 81920
    s_lshl_b32 s50, s50, 7
    buffer_load_dwordx4 v10, s[32:35], s50 offen offset:0 lds
    buffer_load_dwordx4 v11, s[32:35], s50 offen offset:1024 lds
    buffer_load_dwordx4 v12, s[32:35], s50 offen offset:2048 lds
    buffer_load_dwordx4 v13, s[32:35], s50 offen offset:3072 lds
    s_add_u32 s50, s7, 2
    s_and_b32 s50, s50, 7
    s_add_u32 m0, s53, 16384
    s_mul_i32 s51, s50, 196608
    buffer_load_dwordx4 v15, s[36:39], s51 offen lds
    buffer_load_dwordx4 v16, s[36:39], s51 offen offset:1024 lds
    v_mov_b32 v17, 0
    v_mov_b32 v18, 1
    v_mov_b32 v6, 157760
    s_lshr_b32 s58, s3, 3
    s_and_b32 s59, s3, 7
    s_lshl_b32 s60, s4, 1
    s_add_u32 s60, s60, s58
    v_lshrrev_b32 v1, 3, v0
    s_lshl_b32 s30, s6, 4
    v_add_u32 v22, s30, v1
    s_lshl_b32 s30, s60, 16
    s_lshl_b32 s31, s59, 7
    s_add_u32 s30, s30, s31
    v_lshl_add_u32 v1, v22, 10, s30
    v_lshl_add_u32 v20, v3, 4, v1
    v_add_u32 v21, 8192, v20
    s_lshl_b32 s30, s58, 6
    v_add_lshl_u32 v1, v22, s30, 3
    v_add_u32 v23, 157952, v1
    v_lshrrev_b32 v1, 5, v0
    v_bfe_u32 v2, v0, 2, 2
    v_lshl_add_u32 v1, v1, 3, v2
    v_lshlrev_b32 v1, 6, v1
    v_bfe_u32 v2, v0, 4, 1
    v_lshl_add_u32 v1, v2, 5, v1
    v_and_b32 v2, 3, v0
    v_lshl_add_u32 v30, v2, 3, v1
    v_add_u32 v30, 131072, v30
    v_lshrrev_b32 v31, 2, v0
    v_and_b32 v1, 3, v0
    v_lshlrev_b32 v32, 4, v1
    v_lshl_add_u32 v35, v31, 10, v32
    v_add_u32 v33, s31, v35
    v_mul_u32_u24 v1, 3584, v31
    v_add_u32 v34, v1, v32
    v_lshlrev_b32 v36, 2, v0
    v_lshlrev_b32 v37, 3, v0
    v_lshlrev_b32 v38, 4, v0
    v_add_u32 v40, 155648, v36
    v_add_u32 v41, 155648, v38
    v_lshlrev_b32 v1, 1, v0
    v_add_u32 v42, 155648, v1
    v_and_b32 v43, 124, v36
    v_and_b32 v1, 1, v0
    v_lshrrev_b32 v2, 5, v0
    v_lshlrev_b32 v2, 4, v2
    v_lshl_add_u32 v2, v1, 7, v2
    v_add_u32 v39, 161088, v2
    s_and_b32 s30, s3, 1
    s_lshl_b32 s31, s3, 1
    s_or_b32 s30, s30, s31
    v_xor_b32 v1, s30, v0
    v_lshlrev_b32 v44, 7, v1
    s_sub_u32 s73, 384, s10
    s_bfe_u32 s73, s73, 0x30007
    s_waitcnt vmcnt(12)
    s_barrier
    s_waitcnt vmcnt(6)
    s_barrier
    s_add_u32 s50, s7, 2
    s_and_b32 s50, s50, 7
    s_add_u32 m0, s57, 98304
    s_lshl_b32 s50, s50, 7
    buffer_load_dwordx4 v10, s[32:35], s50 offen offset:0 lds
    buffer_load_dwordx4 v11, s[32:35], s50 offen offset:1024 lds
    buffer_load_dwordx4 v12, s[32:35], s50 offen offset:2048 lds
    buffer_load_dwordx4 v13, s[32:35], s50 offen offset:3072 lds
    s_add_u32 s50, s7, 3
    s_and_b32 s50, s50, 7
    s_add_u32 m0, s53, 24576
    s_mul_i32 s51, s50, 196608
    buffer_load_dwordx4 v15, s[36:39], s51 offen lds
    buffer_load_dwordx4 v16, s[36:39], s51 offen offset:1024 lds
    s_waitcnt vmcnt(6)
    s_barrier
    s_add_u32 s50, s7, 3
    s_and_b32 s50, s50, 7
    s_add_u32 m0, s57, 114688
    s_lshl_b32 s50, s50, 7
    buffer_load_dwordx4 v10, s[32:35], s50 offen offset:0 lds
    buffer_load_dwordx4 v11, s[32:35], s50 offen offset:1024 lds
    buffer_load_dwordx4 v12, s[32:35], s50 offen offset:2048 lds
    buffer_load_dwordx4 v13, s[32:35], s50 offen offset:3072 lds
    s_add_u32 s50, s7, 4
    s_and_b32 s50, s50, 7
    s_add_u32 m0, s53, 32768
    s_mul_i32 s51, s50, 196608
    buffer_load_dwordx4 v15, s[36:39], s51 offen lds
    buffer_load_dwordx4 v16, s[36:39], s51 offen offset:1024 lds
    s_waitcnt vmcnt(6)
    s_barrier
    s_add_u32 s50, s7, 4
    s_and_b32 s50, s50, 7
    s_add_u32 m0, s57, 131072
    s_lshl_b32 s50, s50, 7
    buffer_load_dwordx4 v10, s[32:35], s50 offen offset:0 lds
    buffer_load_dwordx4 v11, s[32:35], s50 offen offset:1024 lds
    buffer_load_dwordx4 v12, s[32:35], s50 offen offset:2048 lds
    buffer_load_dwordx4 v13, s[32:35], s50 offen offset:3072 lds
    s_add_u32 s50, s7, 5
    s_and_b32 s50, s50, 7
    s_add_u32 m0, s53, 40960
    s_mul_i32 s51, s50, 196608
    buffer_load_dwordx4 v15, s[36:39], s51 offen lds
    buffer_load_dwordx4 v16, s[36:39], s51 offen offset:1024 lds
    s_waitcnt vmcnt(6)
    s_barrier
    s_add_u32 s50, s7, 5
    s_and_b32 s50, s50, 7
    s_add_u32 m0, s57, 65536
    s_lshl_b32 s50, s50, 7
    buffer_load_dwordx4 v10, s[32:35], s50 offen offset:0 lds
    buffer_load_dwordx4 v11, s[32:35], s50 offen offset:1024 lds
    buffer_load_dwordx4 v12, s[32:35], s50 offen offset:2048 lds
    buffer_load_dwordx4 v13, s[32:35], s50 offen offset:3072 lds
    s_add_u32 s50, s7, 6
    s_and_b32 s50, s50, 7
    s_add_u32 m0, s53, 49152
    s_mul_i32 s51, s50, 196608
    buffer_load_dwordx4 v15, s[36:39], s51 offen lds
    buffer_load_dwordx4 v16, s[36:39], s51 offen offset:1024 lds
    s_lshr_b32 s30, s2, 3
    s_lshl_b32 s30, s30, 2
    s_add_u32 s30, s30, s6
    s_mul_i32 s30, s30, 12288
    s_lshl_b32 s31, s73, 7
    s_add_u32 s30, s30, s31
    s_add_u32 s54, s10, s30
    s_addc_u32 s55, s11, 0
    s_load_dword s76, s[54:55], 0
    s_load_dword s76, s[54:55], 64
    s_load_dword s76, s[54:55], 3072
    s_load_dword s76, s[54:55], 3136
    s_load_dword s76, s[54:55], 6144
    s_load_dword s76, s[54:55], 6208
    s_load_dword s76, s[54:55], 9216
    s_load_dword s76, s[54:55], 9280
    s_waitcnt vmcnt(6)
    s_barrier
    s_add_u32 s50, s7, 6
    s_and_b32 s50, s50, 7
    s_add_u32 m0, s57, 81920
    s_lshl_b32 s50, s50, 7
    buffer_load_dwordx4 v10, s[32:35], s50 offen offset:0 lds
    buffer_load_dwordx4 v11, s[32:35], s50 offen offset:1024 lds
    buffer_load_dwordx4 v12, s[32:35], s50 offen offset:2048 lds
    buffer_load_dwordx4 v13, s[32:35], s50 offen offset:3072 lds
    s_add_u32 s50, s7, 7
    s_and_b32 s50, s50, 7
    s_add_u32 m0, s53, 57344
    s_mul_i32 s51, s50, 196608
    buffer_load_dwordx4 v15, s[36:39], s51 offen lds
    buffer_load_dwordx4 v16, s[36:39], s51 offen offset:1024 lds
    s_waitcnt vmcnt(6)
    s_barrier
    s_add_u32 s50, s7, 7
    s_and_b32 s50, s50, 7
    s_add_u32 m0, s57, 98304
    s_lshl_b32 s50, s50, 7
    buffer_load_dwordx4 v10, s[32:35], s50 offen offset:0 lds
    buffer_load_dwordx4 v11, s[32:35], s50 offen offset:1024 lds
    buffer_load_dwordx4 v12, s[32:35], s50 offen offset:2048 lds
    buffer_load_dwordx4 v13, s[32:35], s50 offen offset:3072 lds
    s_add_u32 s50, s7, 0
    s_and_b32 s50, s50, 7
    s_add_u32 m0, s49, 114688
    s_mul_i32 s51, s50, 196608
    buffer_load_dwordx4 v14, s[36:39], s51 offen lds
    s_add_u32 s50, s7, 1
    s_and_b32 s50, s50, 7
    s_add_u32 m0, s49, 118784
    s_mul_i32 s51, s50, 196608
    buffer_load_dwordx4 v14, s[36:39], s51 offen lds
    s_load_dword s77, s[26:27], 0
    s_waitcnt vmcnt(6)
    s_barrier
    s_add_u32 s50, s7, 2
    s_and_b32 s50, s50, 7
    s_add_u32 m0, s49, 122880
    s_mul_i32 s51, s50, 196608
    buffer_load_dwordx4 v14, s[36:39], s51 offen lds
    s_add_u32 s50, s7, 3
    s_and_b32 s50, s50, 7
    s_add_u32 m0, s49, 126976
    s_mul_i32 s51, s50, 196608
    buffer_load_dwordx4 v14, s[36:39], s51 offen lds
    s_add_u32 s50, s7, 4
    s_and_b32 s50, s50, 7
    s_add_u32 m0, s49, 131072
    s_mul_i32 s51, s50, 196608
    buffer_load_dwordx4 v14, s[36:39], s51 offen lds
    s_waitcnt vmcnt(5)
    s_barrier
    s_add_u32 s50, s7, 5
    s_and_b32 s50, s50, 7
    s_add_u32 m0, s49, 135168
    s_mul_i32 s51, s50, 196608
    buffer_load_dwordx4 v14, s[36:39], s51 offen lds
    s_add_u32 s50, s7, 6
    s_and_b32 s50, s50, 7
    s_add_u32 m0, s49, 139264
    s_mul_i32 s51, s50, 196608
    buffer_load_dwordx4 v14, s[36:39], s51 offen lds
    s_add_u32 s50, s7, 7
    s_and_b32 s50, s50, 7
    s_add_u32 m0, s49, 143360
    s_mul_i32 s51, s50, 196608
    buffer_load_dwordx4 v14, s[36:39], s51 offen lds
    s_mov_b32 s36, s12
    s_mov_b32 s37, s13
    s_mov_b32 s38, 524288
    s_mov_b32 s39, 0x20000
    s_mov_b32 s57, 6309888
    s_or_b32 s54, s4, 1
    s_add_u32 s54, s54, 1
    s_and_b32 s54, s54, 15
    s_lshl_b32 s55, 1, s4
    s_lshl_b32 s52, s3, 8
    s_add_u32 s52, s52, s57
    s_waitcnt lgkmcnt(0)
    s_or_b32 s30, s77, s6
    s_cbranch_scc1 L_h_clrd
    s_mov_b64 s[44:45], s[26:27]
    s_mov_b32 s46, 256
    s_mov_b32 s56, 0
L_h_clr:
    buffer_load_dword v19, v17, s[44:47], 0 offen sc1
    s_add_u32 s56, s56, 1
    s_waitcnt vmcnt(0)
    v_cmp_eq_u32 vcc, 0, v19
    s_cmp_lt_u32 s56, 200000
    s_cbranch_vccz L_h_clrd
    s_cbranch_scc1 L_h_clr
L_h_clrd:
    s_waitcnt vmcnt(0)
    s_mov_b64 exec, 1
    ds_write_b32 v17, v17 offset:6156
    s_mov_b64 exec, -1
    s_waitcnt lgkmcnt(0)
    s_barrier
    s_setprio 3
    s_cmp_lg_u32 s6, 0
    s_cbranch_scc1 L_h_b10
    v_mov_b32 v19, 0
    s_mov_b64 exec, 3
    buffer_atomic_add v19, v44, s[40:43], s57 offen sc0 sc1
    s_mov_b64 exec, -1
    s_waitcnt vmcnt(0)
    v_readlane_b32 s50, v19, 0
    v_readlane_b32 s51, v19, 1
    s_nop 0
    s_and_b32 s30, s50, s51
    s_mul_i32 s30, s30, 0x10001
    s_lshr_b32 s30, s30, s54
    s_and_b32 s30, s30, 0xffff
    s_mov_b64 exec, 1
    v_mov_b32 v19, s30
    ds_write_b32 v17, v19 offset:6156
    s_mov_b64 exec, -1
    s_bcnt1_i32_b32 s53, s30
    s_mov_b32 s56, 0
L_lw_sig:
    ds_read_b32 v19, v6 offset:0
    s_add_u32 s56, s56, 1
    s_waitcnt lgkmcnt(0)
    v_readfirstlane_b32 s30, v19
    s_cmp_ge_u32 s56, 800000
    s_cbranch_scc1 L_lwd_sig
    s_cmp_lt_u32 s30, 4
    s_cbranch_scc1 L_lw_sig
L_lwd_sig:
    v_mov_b32 v19, 0
    s_mov_b64 exec, 5
    v_mov_b32 v19, s55
    s_mov_b64 exec, 7
    buffer_atomic_add v19, v44, s[40:43], s57 offen sc0 sc1
    s_mov_b64 exec, -1
    s_mov_b32 s56, 0
    s_cmp_ge_u32 s53, 1
    s_cbranch_scc1 L_f0d
    s_waitcnt vmcnt(0)
    v_readlane_b32 s50, v19, 0
    v_readlane_b32 s51, v19, 1
    s_bcnt1_i32_b32 s75, s50
    s_or_b32 s50, s50, s55
    s_and_b32 s30, s50, s51
    s_mul_i32 s30, s30, 0x10001
    s_lshr_b32 s30, s30, s54
    s_and_b32 s30, s30, 0xffff
    s_mov_b64 exec, 1
    v_mov_b32 v19, s30
    ds_write_b32 v17, v19 offset:6156
    s_mul_i32 s31, s3, 14
    s_add_u32 s31, s31, s75
    s_cmp_lt_u32 s75, 14
    s_cselect_b32 s75, s31, 255
    s_add_u32 s31, s75, 1
    v_mov_b32 v8, s31
    ds_write_b32 v6, v8 offset:44
    s_mov_b64 exec, -1
L_f0:
    s_add_u32 s56, s56, 1
    s_bcnt1_i32_b32 s53, s30
    s_cmp_ge_u32 s53, 1
    s_cbranch_scc1 L_f0e
    s_cmp_ge_u32 s56, 200000
    s_cbranch_scc1 L_f0e
    v_mov_b32 v19, 0
    s_mov_b64 exec, 3
    buffer_atomic_add v19, v44, s[40:43], s57 offen sc0 sc1
    s_mov_b64 exec, -1
    s_waitcnt vmcnt(0)
    v_readlane_b32 s50, v19, 0
    v_readlane_b32 s51, v19, 1
    s_or_b32 s50, s50, s55
    s_and_b32 s30, s50, s51
    s_mul_i32 s30, s30, 0x10001
    s_lshr_b32 s30, s30, s54
    s_and_b32 s30, s30, 0xffff
    s_mov_b64 exec, 1
    v_mov_b32 v19, s30
    ds_write_b32 v17, v19 offset:6156
    s_mov_b64 exec, -1
    s_branch L_f0
L_f0d:
    s_barrier
    s_waitcnt vmcnt(0)
    v_readlane_b32 s50, v19, 0
    v_readlane_b32 s51, v19, 1
    s_bcnt1_i32_b32 s75, s50
    s_or_b32 s50, s50, s55
    s_and_b32 s30, s50, s51
    s_mul_i32 s30, s30, 0x10001
    s_lshr_b32 s30, s30, s54
    s_and_b32 s30, s30, 0xffff
    s_mov_b64 exec, 1
    v_mov_b32 v19, s30
    ds_write_b32 v17, v19 offset:6156
    s_mul_i32 s31, s3, 14
    s_add_u32 s31, s31, s75
    s_cmp_lt_u32 s75, 14
    s_cselect_b32 s75, s31, 255
    s_add_u32 s31, s75, 1
    v_mov_b32 v8, s31
    ds_write_b32 v6, v8 offset:44
    s_mov_b64 exec, -1
    s_branch L_f1
L_f0e:
    s_barrier
L_f1:
    s_add_u32 s56, s56, 1
    s_cmpk_eq_u32 s30, 0xffff
    s_cbranch_scc1 L_f1d
    s_cmp_ge_u32 s56, 200000
    s_cbranch_scc1 L_f1d
    s_sleep 4
    v_mov_b32 v19, 0
    s_mov_b64 exec, 3
    buffer_atomic_add v19, v44, s[40:43], s57 offen sc0 sc1
    s_mov_b64 exec, -1
    s_waitcnt vmcnt(0)
    v_readlane_b32 s50, v19, 0
    v_readlane_b32 s51, v19, 1
    s_or_b32 s50, s50, s55
    s_and_b32 s30, s50, s51
    s_mul_i32 s30, s30, 0x10001
    s_lshr_b32 s30, s30, s54
    s_and_b32 s30, s30, 0xffff
    s_mov_b64 exec, 1
    v_mov_b32 v19, s30
    ds_write_b32 v17, v19 offset:6156
    s_mov_b64 exec, -1
    s_branch L_f1
L_f1d:
    s_getreg_b32 s50, hwreg(HW_REG_XCC_ID, 0, 4)
    s_or_b32 s50, s50, 0x100
    v_mov_b32 v8, s50
    s_lshl_b32 s63, s4, 7
    s_add_u32 s63, s63, 6299648
    s_lshl_b32 s51, s3, 2
    s_add_u32 s51, s51, s63
    s_mov_b64 exec, 1
    buffer_store_dword v8, v17, s[40:43], s51 offen sc1
    s_mov_b64 exec, -1
    s_mov_b32 s56, 0
L_lw_h0a:
    s_sleep 32
    ds_read_b32 v19, v6 offset:8
    s_add_u32 s56, s56, 1
    s_waitcnt lgkmcnt(0)
    v_readfirstlane_b32 s30, v19
    s_cmp_ge_u32 s56, 800000
    s_cbranch_scc1 L_lwd_h0a
    s_cmp_eq_u32 s30, 0
    s_cbranch_scc1 L_lw_h0a
L_lwd_h0a:
    s_cmpk_lt_u32 s75, 0xe0
    s_cbranch_scc0 L_lwd_h0
    s_mov_b32 s56, 0
L_lw_h0:
    s_sleep 16
    ds_read_b32 v19, v6 offset:40
    s_add_u32 s56, s56, 1
    s_waitcnt lgkmcnt(0)
    v_readfirstlane_b32 s30, v19
    s_cmp_ge_u32 s56, 800000
    s_cbranch_scc1 L_lwd_h0
    s_cmp_eq_u32 s30, 0
    s_cbranch_scc1 L_lw_h0
L_lwd_h0:
    s_mov_b32 s54, 0
L_wo:
    s_add_u32 s50, s54, s60
    s_and_b32 s50, s50, 31
    s_lshl_b32 s51, s50, 10
    s_lshl_b32 s50, s50, 14
    s_add_u32 m0, s51, 65536
    s_add_u32 s52, s50, 64
    buffer_load_dwordx4 v33, s[36:39], s50 offen lds
    s_add_u32 m0, s51, 98304
    s_add_u32 s54, s54, 1
    buffer_load_dwordx4 v33, s[36:39], s52 offen lds
    s_waitcnt vmcnt(6)
    s_cmp_lt_u32 s54, 32
    s_cbranch_scc1 L_wo
    s_mov_b32 s56, 0
    s_mov_b64 exec, 0xffff
L_xid:
    buffer_load_dword v10, v36, s[40:43], s63 offen sc1
    s_add_u32 s56, s56, 1
    s_waitcnt vmcnt(0)
    v_cmp_eq_u32 vcc, 0, v10
    s_cmp_ge_u32 s56, 200000
    s_cbranch_scc1 L_xidd
    s_cbranch_vccnz L_xid
L_xidd:
    v_cmp_ne_u32 vcc, v8, v10
    s_mov_b64 exec, -1
    s_cmp_eq_u64 vcc, 0
    s_cselect_b32 s50, 1, 0
    v_mov_b32 v10, s50
    ds_write_b32 v17, v10 offset:6172
    s_branch L_h_tail
L_h_b10:
    s_barrier
    s_mov_b32 s56, 0
L_lw_role:
    s_sleep 4
    ds_read_b32 v19, v6 offset:44
    s_add_u32 s56, s56, 1
    s_waitcnt lgkmcnt(0)
    v_readfirstlane_b32 s30, v19
    s_cmp_ge_u32 s56, 800000
    s_cbranch_scc1 L_lwd_role
    s_cmp_eq_u32 s30, 0
    s_cbranch_scc1 L_lw_role
L_lwd_role:
    s_sub_u32 s75, s30, 1
    s_lshr_b32 s61, s75, 3
    s_and_b32 s62, s75, 7
    s_cmp_eq_u32 s6, 3
    s_cbranch_scc1 L_h3
    s_cmpk_lt_u32 s75, 0xe0
    s_cbranch_scc0 L_h_tail
    s_cmp_eq_u32 s6, 2
    s_cbranch_scc1 L_h2
    s_mov_b32 s56, 0
L_lw_h1a:
    s_sleep 4
    ds_read_b32 v19, v6 offset:28
    s_add_u32 s56, s56, 1
    s_waitcnt lgkmcnt(0)
    v_readfirstlane_b32 s30, v19
    s_cmp_ge_u32 s56, 800000
    s_cbranch_scc1 L_lwd_h1a
    s_cmp_eq_u32 s30, 0
    s_cbranch_scc1 L_lw_h1a
L_lwd_h1a:
    s_mul_i32 s50, s62, 229376
    s_lshl_b32 s51, s61, 7
    s_add_u32 s50, s50, s51
    s_mov_b32 s44, s18
    s_mov_b32 s45, s19
    s_mov_b32 s46, 1835008
    s_mov_b32 s47, 0x20000
    s_mov_b32 m0, 131072
    s_add_u32 s51, s50, 0
    buffer_load_dwordx4 v34, s[44:47], s51 offen lds
    s_mov_b32 m0, 135168
    s_add_u32 s51, s50, 64
    buffer_load_dwordx4 v34, s[44:47], s51 offen lds
    s_waitcnt vmcnt(4)
    s_mov_b32 m0, 132096
    s_add_u32 s51, s50, 57344
    buffer_load_dwordx4 v34, s[44:47], s51 offen lds
    s_mov_b32 m0, 136192
    s_add_u32 s51, s50, 57408
    buffer_load_dwordx4 v34, s[44:47], s51 offen lds
    s_waitcnt vmcnt(4)
    s_mov_b32 m0, 133120
    s_add_u32 s51, s50, 114688
    buffer_load_dwordx4 v34, s[44:47], s51 offen lds
    s_mov_b32 m0, 137216
    s_add_u32 s51, s50, 114752
    buffer_load_dwordx4 v34, s[44:47], s51 offen lds
    s_waitcnt vmcnt(4)
    s_mov_b32 m0, 134144
    s_add_u32 s51, s50, 172032
    buffer_load_dwordx4 v34, s[44:47], s51 offen lds
    s_mov_b32 m0, 138240
    s_add_u32 s51, s50, 172096
    buffer_load_dwordx4 v34, s[44:47], s51 offen lds
    s_waitcnt vmcnt(4)
    s_mov_b32 s44, s20
    s_mov_b32 s45, s21
    s_mov_b32 s46, 1835008
    s_mov_b32 s47, 0x20000
    s_mov_b32 m0, 139264
    s_add_u32 s51, s50, 0
    buffer_load_dwordx4 v34, s[44:47], s51 offen lds
    s_mov_b32 m0, 143360
    s_add_u32 s51, s50, 64
    buffer_load_dwordx4 v34, s[44:47], s51 offen lds
    s_waitcnt vmcnt(4)
    s_mov_b32 m0, 140288
    s_add_u32 s51, s50, 57344
    buffer_load_dwordx4 v34, s[44:47], s51 offen lds
    s_mov_b32 m0, 144384
    s_add_u32 s51, s50, 57408
    buffer_load_dwordx4 v34, s[44:47], s51 offen lds
    s_waitcnt vmcnt(4)
    s_mov_b32 m0, 141312
    s_add_u32 s51, s50, 114688
    buffer_load_dwordx4 v34, s[44:47], s51 offen lds
    s_mov_b32 m0, 145408
    s_add_u32 s51, s50, 114752
    buffer_load_dwordx4 v34, s[44:47], s51 offen lds
    s_waitcnt vmcnt(4)
    s_mov_b32 m0, 142336
    s_add_u32 s51, s50, 172032
    buffer_load_dwordx4 v34, s[44:47], s51 offen lds
    s_mov_b32 m0, 146432
    s_add_u32 s51, s50, 172096
    buffer_load_dwordx4 v34, s[44:47], s51 offen lds
    s_waitcnt vmcnt(4)
    s_lshl_b32 s50, s75, 10
    s_add_u32 s50, s50, 6815744
    s_lshl_b32 s65, s61, 7
    s_add_u32 s65, s65, 6293504
    s_waitcnt vmcnt(0)
    ds_write_b32 v6, v18 offset:40
    s_mov_b32 s56, 0
L_lw_h1b:
    s_sleep 4
    ds_read_b32 v19, v6 offset:24
    s_add_u32 s56, s56, 1
    s_waitcnt lgkmcnt(0)
    v_readfirstlane_b32 s30, v19
    s_cmp_ge_u32 s56, 800000
    s_cbranch_scc1 L_lwd_h1b
    s_cmp_eq_u32 s30, 0
    s_cbranch_scc1 L_lw_h1b
L_lwd_h1b:
    ds_read_b128 v[48:51], v39 offset:0
    ds_read_b128 v[52:55], v39 offset:32
    ds_read_b128 v[56:59], v39 offset:64
    ds_read_b128 v[60:63], v39 offset:96
    ds_read_b64_tr_b16 v[64:65], v30 offset:0
    ds_read_b64_tr_b16 v[66:67], v30 offset:256
    s_waitcnt lgkmcnt(0)
    v_mfma_f32_32x32x16_bf16 v[72:87], v[48:51], v[64:67], 0
    ds_read_b64_tr_b16 v[64:65], v30 offset:4096
    ds_read_b64_tr_b16 v[66:67], v30 offset:4352
    s_waitcnt lgkmcnt(0)
    v_mfma_f32_32x32x16_bf16 v[88:103], v[48:51], v[64:67], 0
    ds_read_b64_tr_b16 v[64:65], v30 offset:1024
    ds_read_b64_tr_b16 v[66:67], v30 offset:1280
    s_waitcnt lgkmcnt(0)
    v_mfma_f32_32x32x16_bf16 v[72:87], v[52:55], v[64:67], v[72:87]
    ds_read_b64_tr_b16 v[64:65], v30 offset:5120
    ds_read_b64_tr_b16 v[66:67], v30 offset:5376
    s_waitcnt lgkmcnt(0)
    v_mfma_f32_32x32x16_bf16 v[88:103], v[52:55], v[64:67], v[88:103]
    ds_read_b64_tr_b16 v[64:65], v30 offset:2048
    ds_read_b64_tr_b16 v[66:67], v30 offset:2304
    s_waitcnt lgkmcnt(0)
    v_mfma_f32_32x32x16_bf16 v[72:87], v[56:59], v[64:67], v[72:87]
    ds_read_b64_tr_b16 v[64:65], v30 offset:6144
    ds_read_b64_tr_b16 v[66:67], v30 offset:6400
    s_waitcnt lgkmcnt(0)
    v_mfma_f32_32x32x16_bf16 v[88:103], v[56:59], v[64:67], v[88:103]
    ds_read_b64_tr_b16 v[64:65], v30 offset:3072
    ds_read_b64_tr_b16 v[66:67], v30 offset:3328
    s_waitcnt lgkmcnt(0)
    v_mfma_f32_32x32x16_bf16 v[72:87], v[60:63], v[64:67], v[72:87]
    ds_read_b64_tr_b16 v[64:65], v30 offset:7168
    ds_read_b64_tr_b16 v[66:67], v30 offset:7424
    s_waitcnt lgkmcnt(0)
    v_mfma_f32_32x32x16_bf16 v[88:103], v[60:63], v[64:67], v[88:103]
    ds_read_b64_tr_b16 v[64:65], v30 offset:8192
    ds_read_b64_tr_b16 v[66:67], v30 offset:8448
    s_waitcnt lgkmcnt(0)
    v_mfma_f32_32x32x16_bf16 v[104:119], v[48:51], v[64:67], 0
    ds_read_b64_tr_b16 v[64:65], v30 offset:12288
    ds_read_b64_tr_b16 v[66:67], v30 offset:12544
    s_waitcnt lgkmcnt(0)
    v_mfma_f32_32x32x16_bf16 v[120:135], v[48:51], v[64:67], 0
    ds_read_b64_tr_b16 v[64:65], v30 offset:9216
    ds_read_b64_tr_b16 v[66:67], v30 offset:9472
    s_waitcnt lgkmcnt(0)
    v_mfma_f32_32x32x16_bf16 v[104:119], v[52:55], v[64:67], v[104:119]
    ds_read_b64_tr_b16 v[64:65], v30 offset:13312
    ds_read_b64_tr_b16 v[66:67], v30 offset:13568
    s_waitcnt lgkmcnt(0)
    v_mfma_f32_32x32x16_bf16 v[120:135], v[52:55], v[64:67], v[120:135]
    ds_read_b64_tr_b16 v[64:65], v30 offset:10240
    ds_read_b64_tr_b16 v[66:67], v30 offset:10496
    s_waitcnt lgkmcnt(0)
    v_mfma_f32_32x32x16_bf16 v[104:119], v[56:59], v[64:67], v[104:119]
    ds_read_b64_tr_b16 v[64:65], v30 offset:14336
    ds_read_b64_tr_b16 v[66:67], v30 offset:14592
    s_waitcnt lgkmcnt(0)
    v_mfma_f32_32x32x16_bf16 v[120:135], v[56:59], v[64:67], v[120:135]
    ds_read_b64_tr_b16 v[64:65], v30 offset:11264
    ds_read_b64_tr_b16 v[66:67], v30 offset:11520
    s_waitcnt lgkmcnt(0)
    v_mfma_f32_32x32x16_bf16 v[104:119], v[60:63], v[64:67], v[104:119]
    ds_read_b64_tr_b16 v[64:65], v30 offset:15360
    ds_read_b64_tr_b16 v[66:67], v30 offset:15616
    s_waitcnt lgkmcnt(0)
    v_mfma_f32_32x32x16_bf16 v[120:135], v[60:63], v[64:67], v[120:135]
    s_mov_b32 exec_hi, 0
    buffer_store_dwordx2 v[72:73], v38, s[40:43], s50 offen offset:0 sc1
    s_nop 5
    buffer_store_dwordx2 v[104:105], v38, s[40:43], s50 offen offset:8 sc1
    s_not_b64 exec, exec
    buffer_store_dwordx2 v[88:89], v38, s[40:43], s50 offen offset:0 sc1
    s_nop 0
    buffer_store_dwordx2 v[120:121], v38, s[40:43], s50 offen offset:8 sc1
    s_mov_b64 exec, -1
    s_waitcnt vmcnt(0)
    s_mov_b64 exec, 1
    buffer_atomic_add v18, v17, s[40:43], s65 offen sc1
    s_mov_b64 exec, -1
    s_branch L_h_tail
L_h2:
    s_mov_b32 s56, 0
L_lw_h2:
    s_sleep 16
    ds_read_b32 v19, v6 offset:40
    s_add_u32 s56, s56, 1
    s_waitcnt lgkmcnt(0)
    v_readfirstlane_b32 s30, v19
    s_cmp_ge_u32 s56, 800000
    s_cbranch_scc1 L_lwd_h2
    s_cmp_eq_u32 s30, 0
    s_cbranch_scc1 L_lw_h2
L_lwd_h2:
    s_lshl_b32 s50, s61, 16
    s_lshl_b32 s51, s62, 7
    s_add_u32 s50, s50, s51
    s_mov_b32 s44, s22
    s_mov_b32 s45, s23
    s_mov_b32 s46, 1835008
    s_mov_b32 s47, 0x20000
    s_mov_b32 m0, 147456
    s_add_u32 s51, s50, 0
    buffer_load_dwordx4 v35, s[44:47], s51 offen lds
    s_mov_b32 m0, 151552
    s_add_u32 s51, s50, 64
    buffer_load_dwordx4 v35, s[44:47], s51 offen lds
    s_mov_b32 m0, 148480
    s_add_u32 s51, s50, 16384
    buffer_load_dwordx4 v35, s[44:47], s51 offen lds
    s_mov_b32 m0, 152576
    s_add_u32 s51, s50, 16448
    buffer_load_dwordx4 v35, s[44:47], s51 offen lds
    s_mov_b32 m0, 149504
    s_add_u32 s51, s50, 32768
    buffer_load_dwordx4 v35, s[44:47], s51 offen lds
    s_mov_b32 m0, 153600
    s_add_u32 s51, s50, 32832
    buffer_load_dwordx4 v35, s[44:47], s51 offen lds
    s_mov_b32 m0, 150528
    s_add_u32 s51, s50, 49152
    buffer_load_dwordx4 v35, s[44:47], s51 offen lds
    s_mov_b32 m0, 154624
    s_add_u32 s51, s50, 49216
    buffer_load_dwordx4 v35, s[44:47], s51 offen lds
    s_lshl_b32 s65, s61, 7
    s_add_u32 s65, s65, 6293504
    s_mov_b32 s56, 0
    s_mov_b64 exec, 1
L_poll_f3:
    v_mov_b32 v19, 0
    buffer_atomic_add v19, v17, s[40:43], s65 offen sc0 sc1
    s_waitcnt vmcnt(0)
    v_readfirstlane_b32 s30, v19
    s_add_u32 s56, s56, 1
    s_cmp_ge_u32 s30, 8
    s_cbranch_scc1 L_polld_f3
    s_sleep 16
    s_cmp_lt_u32 s56, 200000
    s_cbranch_scc1 L_poll_f3
L_polld_f3:
    s_mov_b64 exec, -1
    s_lshl_b32 s50, s61, 13
    s_add_u32 s50, s50, 6815744
    s_add_u32 s51, s50, 4096
    buffer_load_dwordx4 v[72:75], v38, s[40:43], s50 offen offset:0 sc1
    buffer_load_dwordx4 v[76:79], v38, s[40:43], s50 offen offset:1024 sc1
    buffer_load_dwordx4 v[80:83], v38, s[40:43], s50 offen offset:2048 sc1
    buffer_load_dwordx4 v[84:87], v38, s[40:43], s50 offen offset:3072 sc1
    buffer_load_dwordx4 v[88:91], v38, s[40:43], s51 offen offset:0 sc1
    buffer_load_dwordx4 v[92:95], v38, s[40:43], s51 offen offset:1024 sc1
    buffer_load_dwordx4 v[96:99], v38, s[40:43], s51 offen offset:2048 sc1
    buffer_load_dwordx4 v[100:103], v38, s[40:43], s51 offen offset:3072 sc1
    s_waitcnt vmcnt(0)
    v_add_f32 v72, v72, v76
    v_add_f32 v73, v73, v77
    v_add_f32 v74, v74, v78
    v_add_f32 v75, v75, v79
    v_add_f32 v72, v72, v80
    v_add_f32 v73, v73, v81
    v_add_f32 v74, v74, v82
    v_add_f32 v75, v75, v83
    v_add_f32 v72, v72, v84
    v_add_f32 v73, v73, v85
    v_add_f32 v74, v74, v86
    v_add_f32 v75, v75, v87
    v_add_f32 v72, v72, v88
    v_add_f32 v73, v73, v89
    v_add_f32 v74, v74, v90
    v_add_f32 v75, v75, v91
    v_add_f32 v72, v72, v92
    v_add_f32 v73, v73, v93
    v_add_f32 v74, v74, v94
    v_add_f32 v75, v75, v95
    v_add_f32 v72, v72, v96
    v_add_f32 v73, v73, v97
    v_add_f32 v74, v74, v98
    v_add_f32 v75, v75, v99
    v_add_f32 v72, v72, v100
    v_add_f32 v73, v73, v101
    v_add_f32 v74, v74, v102
    v_add_f32 v75, v75, v103
    v_cvt_pk_bf16_f32 v72, 0, v72
    v_cvt_pk_bf16_f32 v73, 0, v73
    v_cvt_pk_bf16_f32 v74, 0, v74
    v_cvt_pk_bf16_f32 v75, 0, v75
    v_mul_f32 v76, 0xbfb8aa3b, v72
    v_mul_f32 v77, 0xbfb8aa3b, v73
    v_exp_f32 v76, v76
    v_exp_f32 v77, v77
    v_add_f32 v76, 1.0, v76
    v_add_f32 v77, 1.0, v77
    v_rcp_f32 v76, v76
    v_rcp_f32 v77, v77
    v_mul_f32 v76, v76, v72
    v_mul_f32 v77, v77, v73
    v_cvt_pk_bf16_f32 v76, 0, v76
    v_cvt_pk_bf16_f32 v77, 0, v77
    v_mul_f32 v76, v76, v74
    v_mul_f32 v77, v77, v75
    v_cvt_pk_bf16_f32 v76, v76, v77
    ds_write_b16 v42, v76 offset:5696
    ds_write_b16_d16_hi v42, v76 offset:5824
    ds_read_b128 v[48:51], v39 offset:256
    ds_read_b128 v[52:55], v39 offset:288
    ds_read_b128 v[56:59], v39 offset:320
    ds_read_b128 v[60:63], v39 offset:352
    ds_read_b64_tr_b16 v[64:65], v30 offset:16384
    ds_read_b64_tr_b16 v[66:67], v30 offset:16640
    s_waitcnt lgkmcnt(0)
    v_mfma_f32_32x32x16_bf16 v[104:119], v[48:51], v[64:67], 0
    ds_read_b64_tr_b16 v[64:65], v30 offset:20480
    ds_read_b64_tr_b16 v[66:67], v30 offset:20736
    s_waitcnt lgkmcnt(0)
    v_mfma_f32_32x32x16_bf16 v[120:135], v[48:51], v[64:67], 0
    ds_read_b64_tr_b16 v[64:65], v30 offset:17408
    ds_read_b64_tr_b16 v[66:67], v30 offset:17664
    s_waitcnt lgkmcnt(0)
    v_mfma_f32_32x32x16_bf16 v[104:119], v[52:55], v[64:67], v[104:119]
    ds_read_b64_tr_b16 v[64:65], v30 offset:21504
    ds_read_b64_tr_b16 v[66:67], v30 offset:21760
    s_waitcnt lgkmcnt(0)
    v_mfma_f32_32x32x16_bf16 v[120:135], v[52:55], v[64:67], v[120:135]
    ds_read_b64_tr_b16 v[64:65], v30 offset:18432
    ds_read_b64_tr_b16 v[66:67], v30 offset:18688
    s_waitcnt lgkmcnt(0)
    v_mfma_f32_32x32x16_bf16 v[104:119], v[56:59], v[64:67], v[104:119]
    ds_read_b64_tr_b16 v[64:65], v30 offset:22528
    ds_read_b64_tr_b16 v[66:67], v30 offset:22784
    s_waitcnt lgkmcnt(0)
    v_mfma_f32_32x32x16_bf16 v[120:135], v[56:59], v[64:67], v[120:135]
    ds_read_b64_tr_b16 v[64:65], v30 offset:19456
    ds_read_b64_tr_b16 v[66:67], v30 offset:19712
    s_waitcnt lgkmcnt(0)
    v_mfma_f32_32x32x16_bf16 v[104:119], v[60:63], v[64:67], v[104:119]
    ds_read_b64_tr_b16 v[64:65], v30 offset:23552
    ds_read_b64_tr_b16 v[66:67], v30 offset:23808
    s_waitcnt lgkmcnt(0)
    v_mfma_f32_32x32x16_bf16 v[120:135], v[60:63], v[64:67], v[120:135]
    s_lshl_b32 s50, s61, 11
    s_lshl_b32 s51, s62, 8
    s_add_u32 s50, s50, s51
    s_add_u32 s50, s50, 7077888
    s_add_u32 s51, s50, 57344
    s_lshl_b32 s65, s62, 7
    s_add_u32 s65, s65, 6297600
    s_mov_b32 exec_hi, 0
    buffer_store_dword v104, v36, s[40:43], s50 offen sc1
    buffer_store_dword v105, v36, s[40:43], s51 offen sc1
    s_not_b64 exec, exec
    s_nop 0
    buffer_store_dword v120, v36, s[40:43], s50 offen sc1
    buffer_store_dword v121, v36, s[40:43], s51 offen sc1
    s_mov_b64 exec, -1
    s_waitcnt vmcnt(0)
    s_mov_b64 exec, 1
    buffer_atomic_add v18, v17, s[40:43], s65 offen sc1
    s_mov_b64 exec, -1
    s_branch L_h_tail
L_more0:
    s_mov_b32 s56, 0
L_morel0:
    ds_read_b32 v161, v167 offset:6156
    s_add_u32 s56, s56, 1
    s_waitcnt lgkmcnt(0)
    v_readfirstlane_b32 s30, v161
    s_nop 0
    s_andn2_b32 s76, s30, s77
    s_cselect_b32 s77, s30, s77
    s_cbranch_scc1 L_have0
    s_sleep 1
    s_cmp_lt_u32 s56, 1600000
    s_cbranch_scc1 L_morel0
    s_mov_b32 s76, 1
    s_branch L_have0
L_more1:
    s_mov_b32 s56, 0
L_morel1:
    ds_read_b32 v161, v167 offset:6156
    s_add_u32 s56, s56, 1
    s_waitcnt lgkmcnt(0)
    v_readfirstlane_b32 s30, v161
    s_nop 0
    s_andn2_b32 s76, s30, s77
    s_cselect_b32 s77, s30, s77
    s_cbranch_scc1 L_have1
    s_sleep 1
    s_cmp_lt_u32 s56, 1600000
    s_cbranch_scc1 L_morel1
    s_mov_b32 s76, 1
    s_branch L_have1
L_more2:
    s_mov_b32 s56, 0
L_morel2:
    ds_read_b32 v161, v167 offset:6156
    s_add_u32 s56, s56, 1
    s_waitcnt lgkmcnt(0)
    v_readfirstlane_b32 s30, v161
    s_nop 0
    s_andn2_b32 s76, s30, s77
    s_cselect_b32 s77, s30, s77
    s_cbranch_scc1 L_have2
    s_sleep 1
    s_cmp_lt_u32 s56, 1600000
    s_cbranch_scc1 L_morel2
    s_mov_b32 s76, 1
    s_branch L_have2
L_more3:
    s_mov_b32 s56, 0
L_morel3:
    ds_read_b32 v161, v167 offset:6156
    s_add_u32 s56, s56, 1
    s_waitcnt lgkmcnt(0)
    v_readfirstlane_b32 s30, v161
    s_nop 0
    s_andn2_b32 s76, s30, s77
    s_cselect_b32 s77, s30, s77
    s_cbranch_scc1 L_have3
    s_sleep 1
    s_cmp_lt_u32 s56, 1600000
    s_cbranch_scc1 L_morel3
    s_mov_b32 s76, 1
    s_branch L_have3
L_more4:
    s_mov_b32 s56, 0
L_morel4:
    ds_read_b32 v161, v167 offset:6156
    s_add_u32 s56, s56, 1
    s_waitcnt lgkmcnt(0)
    v_readfirstlane_b32 s30, v161
    s_nop 0
    s_andn2_b32 s76, s30, s77
    s_cselect_b32 s77, s30, s77
    s_cbranch_scc1 L_have4
    s_sleep 1
    s_cmp_lt_u32 s56, 1600000
    s_cbranch_scc1 L_morel4
    s_mov_b32 s76, 1
    s_branch L_have4
L_more5:
    s_mov_b32 s56, 0
L_morel5:
    ds_read_b32 v161, v167 offset:6156
    s_add_u32 s56, s56, 1
    s_waitcnt lgkmcnt(0)
    v_readfirstlane_b32 s30, v161
    s_nop 0
    s_andn2_b32 s76, s30, s77
    s_cselect_b32 s77, s30, s77
    s_cbranch_scc1 L_have5
    s_sleep 1
    s_cmp_lt_u32 s56, 1600000
    s_cbranch_scc1 L_morel5
    s_mov_b32 s76, 1
    s_branch L_have5
L_more6:
    s_mov_b32 s56, 0
L_morel6:
    ds_read_b32 v161, v167 offset:6156
    s_add_u32 s56, s56, 1
    s_waitcnt lgkmcnt(0)
    v_readfirstlane_b32 s30, v161
    s_nop 0
    s_andn2_b32 s76, s30, s77
    s_cselect_b32 s77, s30, s77
    s_cbranch_scc1 L_have6
    s_sleep 1
    s_cmp_lt_u32 s56, 1600000
    s_cbranch_scc1 L_morel6
    s_mov_b32 s76, 1
    s_branch L_have6
L_more7:
    s_mov_b32 s56, 0
L_morel7:
    ds_read_b32 v161, v167 offset:6156
    s_add_u32 s56, s56, 1
    s_waitcnt lgkmcnt(0)
    v_readfirstlane_b32 s30, v161
    s_nop 0
    s_andn2_b32 s76, s30, s77
    s_cselect_b32 s77, s30, s77
    s_cbranch_scc1 L_have7
    s_sleep 1
    s_cmp_lt_u32 s56, 1600000
    s_cbranch_scc1 L_morel7
    s_mov_b32 s76, 1
    s_branch L_have7
L_more8:
    s_mov_b32 s56, 0
L_morel8:
    ds_read_b32 v161, v167 offset:6156
    s_add_u32 s56, s56, 1
    s_waitcnt lgkmcnt(0)
    v_readfirstlane_b32 s30, v161
    s_nop 0
    s_andn2_b32 s76, s30, s77
    s_cselect_b32 s77, s30, s77
    s_cbranch_scc1 L_have8
    s_sleep 1
    s_cmp_lt_u32 s56, 1600000
    s_cbranch_scc1 L_morel8
    s_mov_b32 s76, 1
    s_branch L_have8
.fill ((2176 - (. - recurrent_scan__softmax_full_mha__moe_arch_mod__prompt_kernel)) & 0xfff) >> 2, 4, 0xbf800000
L_h3:
    ds_read_b128 v[48:51], v41 offset:2304
    ds_read_b32 v52, v40 offset:2176
    s_mov_b32 s63, 6422528
    s_lshl_b32 s50, s4, 10
    s_add_u32 s50, s50, s63
    s_mov_b32 s64, 6356992
    s_lshl_b32 s51, s4, 5
    s_add_u32 s51, s51, s64
    s_mov_b32 s52, 6291456
    s_lshl_b32 s65, s3, 7
    s_add_u32 s65, s65, s52
    s_cmp_lg_u32 s3, s4
    s_cbranch_scc1 L_h3_nopub
    v_lshlrev_b32 v53, 7, v0
    s_waitcnt lgkmcnt(0)
    buffer_store_dwordx4 v[48:51], v38, s[40:43], s50 offen sc1
    s_mov_b64 exec, 0xff
    buffer_store_dword v52, v36, s[40:43], s51 offen sc1
    s_mov_b64 exec, 0xffff
    s_waitcnt vmcnt(0)
    buffer_atomic_add v18, v53, s[40:43], s52 offen sc1
    s_mov_b64 exec, -1
L_h3_nopub:
    s_mov_b32 s56, 0
L_lw_h3:
    s_sleep 4
    ds_read_b32 v19, v17 offset:6156
    s_add_u32 s56, s56, 1
    s_waitcnt lgkmcnt(0)
    v_readfirstlane_b32 s30, v19
    s_cmp_ge_u32 s56, 800000
    s_cbranch_scc1 L_lwd_h3
    s_cmpk_lg_u32 s30, 0xffff
    s_cbranch_scc1 L_lw_h3
L_lwd_h3:
    s_mov_b32 s56, 0
    s_mov_b64 exec, 1
L_poll_f2:
    v_mov_b32 v19, 0
    buffer_atomic_add v19, v17, s[40:43], s65 offen sc0 sc1
    s_waitcnt vmcnt(0)
    v_readfirstlane_b32 s30, v19
    s_add_u32 s56, s56, 1
    s_cmp_ge_u32 s30, 16
    s_cbranch_scc1 L_polld_f2
    s_sleep 8
    s_cmp_lt_u32 s56, 200000
    s_cbranch_scc1 L_poll_f2
L_polld_f2:
    s_mov_b64 exec, -1
    ds_write_b32 v6, v18 offset:28
    buffer_load_dwordx2 v[48:49], v37, s[40:43], s64 offen sc1
    s_waitcnt vmcnt(0)
    ds_max_u32 v6, v48 offset:32
    ds_read_b32 v50, v6 offset:32
    s_waitcnt lgkmcnt(0)
    v_cmp_eq_u32 vcc, v50, v48
    v_readfirstlane_b32 s66, v50
    s_nop 0
    v_cndmask_b32_e64 v48, v48, v49, vcc
    ds_max_u32 v6, v48 offset:36
    ds_read_b32 v51, v6 offset:36
    s_waitcnt lgkmcnt(0)
    ds_write_b64 v6, v[50:51] offset:8
    v_readfirstlane_b32 s67, v51
    s_cmpk_lt_u32 s75, 0xe0
    s_cbranch_scc0 L_h3_y
    s_and_b32 s50, s66, 0x7ff
    s_sub_u32 s50, 0x7ff, s50
    s_and_b32 s51, s67, 0x7ff
    s_sub_u32 s51, 0x7ff, s51
    s_lshl_b32 s30, s62, 7
    s_lshl_b32 s52, s50, 10
    s_add_u32 s52, s52, s30
    s_lshl_b32 s53, s51, 10
    s_add_u32 s53, s53, s30
    s_lshl_b32 s50, s50, 3
    s_add_u32 s50, s50, s63
    s_lshl_b32 s51, s51, 3
    s_add_u32 s51, s51, s63
    s_mov_b32 exec_hi, 0
    buffer_load_dwordx2 v[48:49], v17, s[40:43], s50 offen sc1
    buffer_load_dword v50, v43, s[32:35], s52 offen
    s_not_b64 exec, exec
    buffer_load_dwordx2 v[48:49], v17, s[40:43], s51 offen sc1
    buffer_load_dword v50, v43, s[32:35], s53 offen
    s_mov_b64 exec, -1
    s_waitcnt vmcnt(0)
    v_lshlrev_b32 v52, 16, v50
    v_and_b32 v53, 0xffff0000, v50
    v_sub_f32 v52, v52, v48
    v_sub_f32 v53, v53, v48
    v_cvt_pk_bf16_f32 v52, 0, v52
    v_cvt_pk_bf16_f32 v53, 0, v53
    v_mul_f32 v52, v52, v49
    v_mul_f32 v53, v53, v49
    v_cvt_pk_bf16_f32 v52, v52, v53
    ds_write_b32 v40, v52 offset:5440
    ds_write_b32 v6, v18 offset:24
L_h3_y:
    s_lshl_b32 s65, s59, 7
    s_add_u32 s65, s65, 6297600
    s_mov_b32 s68, 0
L_h3_sel:
    s_and_b32 s50, s66, 0x7ff
    s_sub_u32 s50, 0x7ff, s50
    s_lshr_b32 s50, s50, 6
    s_cmp_lg_u32 s50, s60
    s_cbranch_scc1 L_h3_next
    s_mov_b32 s56, 0
    s_mov_b64 exec, 1
L_poll_f4:
    v_mov_b32 v19, 0
    buffer_atomic_add v19, v17, s[40:43], s65 offen sc0 sc1
    s_waitcnt vmcnt(0)
    v_readfirstlane_b32 s30, v19
    s_add_u32 s56, s56, 1
    s_cmp_ge_u32 s30, 28
    s_cbranch_scc1 L_polld_f4
    s_sleep 16
    s_cmp_lt_u32 s56, 200000
    s_cbranch_scc1 L_poll_f4
L_polld_f4:
    s_mov_b64 exec, -1
    s_mul_i32 s50, s68, 57344
    s_lshl_b32 s51, s59, 8
    s_add_u32 s50, s50, s51
    s_add_u32 s50, s50, 7077888
    buffer_load_dword v48, v36, s[40:43], s50 offen offset:0 sc1
    buffer_load_dword v49, v36, s[40:43], s50 offen offset:2048 sc1
    s_add_u32 s50, s50, 4096
    buffer_load_dword v50, v36, s[40:43], s50 offen offset:0 sc1
    buffer_load_dword v51, v36, s[40:43], s50 offen offset:2048 sc1
    s_add_u32 s50, s50, 4096
    buffer_load_dword v52, v36, s[40:43], s50 offen offset:0 sc1
    buffer_load_dword v53, v36, s[40:43], s50 offen offset:2048 sc1
    s_add_u32 s50, s50, 4096
    buffer_load_dword v54, v36, s[40:43], s50 offen offset:0 sc1
    buffer_load_dword v55, v36, s[40:43], s50 offen offset:2048 sc1
    s_add_u32 s50, s50, 4096
    buffer_load_dword v56, v36, s[40:43], s50 offen offset:0 sc1
    buffer_load_dword v57, v36, s[40:43], s50 offen offset:2048 sc1
    s_add_u32 s50, s50, 4096
    buffer_load_dword v58, v36, s[40:43], s50 offen offset:0 sc1
    buffer_load_dword v59, v36, s[40:43], s50 offen offset:2048 sc1
    s_add_u32 s50, s50, 4096
    buffer_load_dword v60, v36, s[40:43], s50 offen offset:0 sc1
    buffer_load_dword v61, v36, s[40:43], s50 offen offset:2048 sc1
    s_add_u32 s50, s50, 4096
    buffer_load_dword v62, v36, s[40:43], s50 offen offset:0 sc1
    buffer_load_dword v63, v36, s[40:43], s50 offen offset:2048 sc1
    s_add_u32 s50, s50, 4096
    buffer_load_dword v64, v36, s[40:43], s50 offen offset:0 sc1
    buffer_load_dword v65, v36, s[40:43], s50 offen offset:2048 sc1
    s_add_u32 s50, s50, 4096
    buffer_load_dword v66, v36, s[40:43], s50 offen offset:0 sc1
    buffer_load_dword v67, v36, s[40:43], s50 offen offset:2048 sc1
    s_add_u32 s50, s50, 4096
    buffer_load_dword v68, v36, s[40:43], s50 offen offset:0 sc1
    buffer_load_dword v69, v36, s[40:43], s50 offen offset:2048 sc1
    s_add_u32 s50, s50, 4096
    buffer_load_dword v70, v36, s[40:43], s50 offen offset:0 sc1
    buffer_load_dword v71, v36, s[40:43], s50 offen offset:2048 sc1
    s_add_u32 s50, s50, 4096
    buffer_load_dword v72, v36, s[40:43], s50 offen offset:0 sc1
    buffer_load_dword v73, v36, s[40:43], s50 offen offset:2048 sc1
    s_add_u32 s50, s50, 4096
    buffer_load_dword v74, v36, s[40:43], s50 offen offset:0 sc1
    buffer_load_dword v75, v36, s[40:43], s50 offen offset:2048 sc1
    s_add_u32 s50, s50, 4096
    s_and_b32 s51, s66, 0xffff0000
    s_xor_b32 s52, s51, 0x80000000
    s_xor_b32 s53, s51, 0xffff0000
    s_bitcmp1_b32 s51, 31
    s_cselect_b32 s51, s52, s53
    v_mov_b32 v4, 0xbfb8aa3b
    v_mul_f32 v4, s51, v4
    v_exp_f32 v4, v4
    s_lshl_b32 s51, s68, 8
    v_add_u32 v7, s51, v40
    v_add_f32 v4, 1.0, v4
    v_rcp_f32 v4, v4
    s_waitcnt vmcnt(0)
    v_cvt_pk_bf16_f32 v4, 0, v4
    v_add_f32 v48, v48, v49
    v_add_f32 v48, v48, v50
    v_add_f32 v48, v48, v51
    v_add_f32 v48, v48, v52
    v_add_f32 v48, v48, v53
    v_add_f32 v48, v48, v54
    v_add_f32 v48, v48, v55
    v_add_f32 v48, v48, v56
    v_add_f32 v48, v48, v57
    v_add_f32 v48, v48, v58
    v_add_f32 v48, v48, v59
    v_add_f32 v48, v48, v60
    v_add_f32 v48, v48, v61
    v_add_f32 v48, v48, v62
    v_add_f32 v48, v48, v63
    v_add_f32 v48, v48, v64
    v_add_f32 v48, v48, v65
    v_add_f32 v48, v48, v66
    v_add_f32 v48, v48, v67
    v_add_f32 v48, v48, v68
    v_add_f32 v48, v48, v69
    v_add_f32 v48, v48, v70
    v_add_f32 v48, v48, v71
    v_add_f32 v48, v48, v72
    v_add_f32 v48, v48, v73
    v_add_f32 v48, v48, v74
    v_add_f32 v48, v48, v75
    v_cvt_pk_bf16_f32 v48, 0, v48
    v_mul_f32 v48, v48, v4
    v_cvt_pk_bf16_f32 v48, 0, v48
    ds_write_b32 v7, v48 offset:6144
L_h3_next:
    s_mov_b32 s66, s67
    s_add_u32 s68, s68, 1
    s_cmp_lt_u32 s68, 2
    s_cbranch_scc1 L_h3_sel
L_h_tail:
    buffer_load_dwordx4 v[136:139], v20, s[32:35], 0 offen
    buffer_load_dwordx4 v[140:143], v21, s[32:35], 0 offen
    ds_read_b64 v[24:25], v23
    ds_read_b64 v[26:27], v23 offset:64
    s_mov_b32 s44, s24
    s_mov_b32 s45, s25
    s_mov_b32 s46, 2097152
    s_mov_b32 s47, 0x20000
    s_setprio 0
    s_waitcnt vmcnt(0) lgkmcnt(0)
    s_barrier
    ds_read_b64 v[4:5], v6 offset:8
    s_barrier
    v_lshlrev_b32 v48, 16, v136
    v_and_b32 v49, 0xffff0000, v136
    v_lshlrev_b32 v50, 16, v137
    v_and_b32 v51, 0xffff0000, v137
    v_lshlrev_b32 v52, 16, v138
    v_and_b32 v53, 0xffff0000, v138
    v_lshlrev_b32 v54, 16, v139
    v_and_b32 v55, 0xffff0000, v139
    v_lshlrev_b32 v56, 16, v140
    v_and_b32 v57, 0xffff0000, v140
    v_lshlrev_b32 v58, 16, v141
    v_and_b32 v59, 0xffff0000, v141
    v_lshlrev_b32 v60, 16, v142
    v_and_b32 v61, 0xffff0000, v142
    v_lshlrev_b32 v62, 16, v143
    v_and_b32 v63, 0xffff0000, v143
    v_pk_add_f32 v[64:65], v[48:49], v[24:25] op_sel_hi:[1,0] neg_lo:[0,1] neg_hi:[0,1]
    v_pk_add_f32 v[66:67], v[50:51], v[24:25] op_sel_hi:[1,0] neg_lo:[0,1] neg_hi:[0,1]
    v_pk_add_f32 v[68:69], v[52:53], v[24:25] op_sel_hi:[1,0] neg_lo:[0,1] neg_hi:[0,1]
    v_pk_add_f32 v[70:71], v[54:55], v[24:25] op_sel_hi:[1,0] neg_lo:[0,1] neg_hi:[0,1]
    v_pk_add_f32 v[72:73], v[56:57], v[26:27] op_sel_hi:[1,0] neg_lo:[0,1] neg_hi:[0,1]
    v_pk_add_f32 v[74:75], v[58:59], v[26:27] op_sel_hi:[1,0] neg_lo:[0,1] neg_hi:[0,1]
    v_pk_add_f32 v[76:77], v[60:61], v[26:27] op_sel_hi:[1,0] neg_lo:[0,1] neg_hi:[0,1]
    v_pk_add_f32 v[78:79], v[62:63], v[26:27] op_sel_hi:[1,0] neg_lo:[0,1] neg_hi:[0,1]
    v_cvt_pk_bf16_f32 v64, 0, v64
    v_cvt_pk_bf16_f32 v65, 0, v65
    v_cvt_pk_bf16_f32 v66, 0, v66
    v_cvt_pk_bf16_f32 v67, 0, v67
    v_cvt_pk_bf16_f32 v68, 0, v68
    v_cvt_pk_bf16_f32 v69, 0, v69
    v_cvt_pk_bf16_f32 v70, 0, v70
    v_cvt_pk_bf16_f32 v71, 0, v71
    v_cvt_pk_bf16_f32 v72, 0, v72
    v_cvt_pk_bf16_f32 v73, 0, v73
    v_cvt_pk_bf16_f32 v74, 0, v74
    v_cvt_pk_bf16_f32 v75, 0, v75
    v_cvt_pk_bf16_f32 v76, 0, v76
    v_cvt_pk_bf16_f32 v77, 0, v77
    v_cvt_pk_bf16_f32 v78, 0, v78
    v_cvt_pk_bf16_f32 v79, 0, v79
    v_pk_mul_f32 v[64:65], v[24:25], v[64:65] op_sel:[1,0]
    v_pk_mul_f32 v[66:67], v[24:25], v[66:67] op_sel:[1,0]
    v_pk_mul_f32 v[68:69], v[24:25], v[68:69] op_sel:[1,0]
    v_pk_mul_f32 v[70:71], v[24:25], v[70:71] op_sel:[1,0]
    v_pk_mul_f32 v[72:73], v[26:27], v[72:73] op_sel:[1,0]
    v_pk_mul_f32 v[74:75], v[26:27], v[74:75] op_sel:[1,0]
    v_pk_mul_f32 v[76:77], v[26:27], v[76:77] op_sel:[1,0]
    v_pk_mul_f32 v[78:79], v[26:27], v[78:79] op_sel:[1,0]
    v_cvt_pk_bf16_f32 v64, 0, v64
    v_cvt_pk_bf16_f32 v65, 0, v65
    v_cvt_pk_bf16_f32 v66, 0, v66
    v_cvt_pk_bf16_f32 v67, 0, v67
    v_cvt_pk_bf16_f32 v68, 0, v68
    v_cvt_pk_bf16_f32 v69, 0, v69
    v_cvt_pk_bf16_f32 v70, 0, v70
    v_cvt_pk_bf16_f32 v71, 0, v71
    v_cvt_pk_bf16_f32 v72, 0, v72
    v_cvt_pk_bf16_f32 v73, 0, v73
    v_cvt_pk_bf16_f32 v74, 0, v74
    v_cvt_pk_bf16_f32 v75, 0, v75
    v_cvt_pk_bf16_f32 v76, 0, v76
    v_cvt_pk_bf16_f32 v77, 0, v77
    v_cvt_pk_bf16_f32 v78, 0, v78
    v_cvt_pk_bf16_f32 v79, 0, v79
    v_lshlrev_b32 v7, 5, v3
    v_add_u32 v7, 161792, v7
    s_mov_b32 s68, 0
    s_waitcnt lgkmcnt(0)
    v_readfirstlane_b32 s66, v4
    v_readfirstlane_b32 s67, v5
L_ht_sel:
    s_and_b32 s50, s66, 0x7ff
    s_sub_u32 s50, 0x7ff, s50
    s_lshr_b32 s51, s50, 6
    s_cmp_lg_u32 s51, s60
    s_cbranch_scc1 L_ht_next
    s_and_b32 s50, s50, 63
    ds_read_b128 v[8:11], v7
    ds_read_b128 v[12:15], v7 offset:16
    s_sub_u32 s51, s50, 8
    v_cmp_eq_u32 s[52:53], s50, v22
    v_cmp_eq_u32 s[54:55], s51, v22
    s_waitcnt lgkmcnt(0)
    s_mov_b64 exec, s[52:53]
    v_add_f32 v64, v64, v8
    v_add_f32 v65, v65, v9
    v_add_f32 v66, v66, v10
    v_add_f32 v67, v67, v11
    v_add_f32 v68, v68, v12
    v_add_f32 v69, v69, v13
    v_add_f32 v70, v70, v14
    v_add_f32 v71, v71, v15
    v_cvt_pk_bf16_f32 v64, 0, v64
    v_cvt_pk_bf16_f32 v65, 0, v65
    v_cvt_pk_bf16_f32 v66, 0, v66
    v_cvt_pk_bf16_f32 v67, 0, v67
    v_cvt_pk_bf16_f32 v68, 0, v68
    v_cvt_pk_bf16_f32 v69, 0, v69
    v_cvt_pk_bf16_f32 v70, 0, v70
    v_cvt_pk_bf16_f32 v71, 0, v71
    s_mov_b64 exec, s[54:55]
    v_add_f32 v72, v72, v8
    v_add_f32 v73, v73, v9
    v_add_f32 v74, v74, v10
    v_add_f32 v75, v75, v11
    v_add_f32 v76, v76, v12
    v_add_f32 v77, v77, v13
    v_add_f32 v78, v78, v14
    v_add_f32 v79, v79, v15
    v_cvt_pk_bf16_f32 v72, 0, v72
    v_cvt_pk_bf16_f32 v73, 0, v73
    v_cvt_pk_bf16_f32 v74, 0, v74
    v_cvt_pk_bf16_f32 v75, 0, v75
    v_cvt_pk_bf16_f32 v76, 0, v76
    v_cvt_pk_bf16_f32 v77, 0, v77
    v_cvt_pk_bf16_f32 v78, 0, v78
    v_cvt_pk_bf16_f32 v79, 0, v79
    s_mov_b64 exec, -1
L_ht_next:
    v_add_u32 v7, 256, v7
    s_mov_b32 s66, s67
    s_add_u32 s68, s68, 1
    s_cmp_lt_u32 s68, 2
    s_cbranch_scc1 L_ht_sel
    s_mov_b32 s50, 0xbfb8aa3b
    v_pk_mul_f32 v[152:153], v[64:65], s[50:51] op_sel_hi:[1,0]
    v_pk_mul_f32 v[154:155], v[66:67], s[50:51] op_sel_hi:[1,0]
    v_pk_mul_f32 v[156:157], v[68:69], s[50:51] op_sel_hi:[1,0]
    v_pk_mul_f32 v[158:159], v[70:71], s[50:51] op_sel_hi:[1,0]
    v_pk_mul_f32 v[160:161], v[72:73], s[50:51] op_sel_hi:[1,0]
    v_pk_mul_f32 v[162:163], v[74:75], s[50:51] op_sel_hi:[1,0]
    v_pk_mul_f32 v[164:165], v[76:77], s[50:51] op_sel_hi:[1,0]
    v_pk_mul_f32 v[166:167], v[78:79], s[50:51] op_sel_hi:[1,0]
    v_exp_f32 v152, v152
    v_exp_f32 v153, v153
    v_exp_f32 v154, v154
    v_exp_f32 v155, v155
    v_exp_f32 v156, v156
    v_exp_f32 v157, v157
    v_exp_f32 v158, v158
    v_exp_f32 v159, v159
    v_exp_f32 v160, v160
    v_exp_f32 v161, v161
    v_exp_f32 v162, v162
    v_exp_f32 v163, v163
    v_exp_f32 v164, v164
    v_exp_f32 v165, v165
    v_exp_f32 v166, v166
    v_exp_f32 v167, v167
    v_pk_add_f32 v[152:153], v[152:153], 1.0 op_sel_hi:[1,0]
    v_pk_add_f32 v[154:155], v[154:155], 1.0 op_sel_hi:[1,0]
    v_pk_add_f32 v[156:157], v[156:157], 1.0 op_sel_hi:[1,0]
    v_pk_add_f32 v[158:159], v[158:159], 1.0 op_sel_hi:[1,0]
    v_pk_add_f32 v[160:161], v[160:161], 1.0 op_sel_hi:[1,0]
    v_pk_add_f32 v[162:163], v[162:163], 1.0 op_sel_hi:[1,0]
    v_pk_add_f32 v[164:165], v[164:165], 1.0 op_sel_hi:[1,0]
    v_pk_add_f32 v[166:167], v[166:167], 1.0 op_sel_hi:[1,0]
    v_rcp_f32 v152, v152
    v_rcp_f32 v153, v153
    v_rcp_f32 v154, v154
    v_rcp_f32 v155, v155
    v_rcp_f32 v156, v156
    v_rcp_f32 v157, v157
    v_rcp_f32 v158, v158
    v_rcp_f32 v159, v159
    v_rcp_f32 v160, v160
    v_rcp_f32 v161, v161
    v_rcp_f32 v162, v162
    v_rcp_f32 v163, v163
    v_rcp_f32 v164, v164
    v_rcp_f32 v165, v165
    v_rcp_f32 v166, v166
    v_rcp_f32 v167, v167
    v_pk_mul_f32 v[152:153], v[152:153], v[64:65]
    v_pk_mul_f32 v[154:155], v[154:155], v[66:67]
    v_pk_mul_f32 v[156:157], v[156:157], v[68:69]
    v_pk_mul_f32 v[158:159], v[158:159], v[70:71]
    v_pk_mul_f32 v[160:161], v[160:161], v[72:73]
    v_pk_mul_f32 v[162:163], v[162:163], v[74:75]
    v_pk_mul_f32 v[164:165], v[164:165], v[76:77]
    v_pk_mul_f32 v[166:167], v[166:167], v[78:79]
    v_and_b32 v2, 7, v22
    v_xor_b32 v2, v3, v2
    v_lshlrev_b32 v4, 7, v22
    v_lshl_add_u32 v4, v2, 4, v4
    v_add_u32 v4, 131072, v4
    s_barrier
    s_barrier
    s_barrier
    s_barrier
    s_barrier
    s_barrier
    s_barrier
    s_barrier
    v_cvt_pk_bf16_f32 v152, 0, v152
    v_cvt_pk_bf16_f32 v153, 0, v153
    v_cvt_pk_bf16_f32 v154, 0, v154
    v_cvt_pk_bf16_f32 v155, 0, v155
    v_cvt_pk_bf16_f32 v156, 0, v156
    v_cvt_pk_bf16_f32 v157, 0, v157
    v_cvt_pk_bf16_f32 v158, 0, v158
    v_cvt_pk_bf16_f32 v159, 0, v159
    v_cvt_pk_bf16_f32 v160, 0, v160
    v_cvt_pk_bf16_f32 v161, 0, v161
    v_cvt_pk_bf16_f32 v162, 0, v162
    v_cvt_pk_bf16_f32 v163, 0, v163
    v_cvt_pk_bf16_f32 v164, 0, v164
    v_cvt_pk_bf16_f32 v165, 0, v165
    v_cvt_pk_bf16_f32 v166, 0, v166
    v_cvt_pk_bf16_f32 v167, 0, v167
    s_barrier
    ds_read_b128 v[8:11], v4
    ds_read_b128 v[12:15], v4 offset:1024
    s_waitcnt lgkmcnt(1)
    v_lshlrev_b32 v24, 16, v8
    v_and_b32 v25, 0xffff0000, v8
    v_lshlrev_b32 v26, 16, v9
    v_and_b32 v27, 0xffff0000, v9
    v_lshlrev_b32 v28, 16, v10
    v_and_b32 v29, 0xffff0000, v10
    v_lshlrev_b32 v30, 16, v11
    v_and_b32 v31, 0xffff0000, v11
    v_pk_fma_f32 v[24:25], v[24:25], v[152:153], v[48:49]
    v_pk_fma_f32 v[26:27], v[26:27], v[154:155], v[50:51]
    v_pk_fma_f32 v[28:29], v[28:29], v[156:157], v[52:53]
    v_pk_fma_f32 v[30:31], v[30:31], v[158:159], v[54:55]
    v_cvt_pk_bf16_f32 v8, v24, v25
    v_cvt_pk_bf16_f32 v9, v26, v27
    v_cvt_pk_bf16_f32 v10, v28, v29
    v_cvt_pk_bf16_f32 v11, v30, v31
    buffer_store_dwordx4 v[8:11], v20, s[44:47], 0 offen
    s_waitcnt lgkmcnt(0)
    v_lshlrev_b32 v24, 16, v12
    v_and_b32 v25, 0xffff0000, v12
    v_lshlrev_b32 v26, 16, v13
    v_and_b32 v27, 0xffff0000, v13
    v_lshlrev_b32 v28, 16, v14
    v_and_b32 v29, 0xffff0000, v14
    v_lshlrev_b32 v30, 16, v15
    v_and_b32 v31, 0xffff0000, v15
    v_pk_fma_f32 v[24:25], v[24:25], v[160:161], v[56:57]
    v_pk_fma_f32 v[26:27], v[26:27], v[162:163], v[58:59]
    v_pk_fma_f32 v[28:29], v[28:29], v[164:165], v[60:61]
    v_pk_fma_f32 v[30:31], v[30:31], v[166:167], v[62:63]
    v_cvt_pk_bf16_f32 v12, v24, v25
    v_cvt_pk_bf16_f32 v13, v26, v27
    v_cvt_pk_bf16_f32 v14, v28, v29
    v_cvt_pk_bf16_f32 v15, v30, v31
    buffer_store_dwordx4 v[12:15], v21, s[44:47], 0 offen
    s_endpgm
L_tail_b:
    v_lshlrev_b32 v3, 2, v166
    s_lshr_b32 s30, s3, 3
    s_lshl_b32 s31, s4, 1
    s_add_u32 s30, s30, s31
    s_lshl_b32 s72, s30, 8
    s_add_u32 s72, s72, 6301696
    s_lshl_b32 s30, s30, 16
    s_lshl_b32 s69, s6, 10
    s_add_u32 s68, s30, s69
    s_add_u32 s68, s68, 4194304
    s_cmp_eq_u32 s70, 0
    s_waitcnt vmcnt(0)
    s_mov_b64 exec, 1
    s_cbranch_scc1 L_of_far_b
    buffer_store_dword v160, v167, s[40:43], s59 offen
    s_branch L_of_done_b
L_of_far_b:
    buffer_store_dword v160, v167, s[40:43], s59 offen sc1
L_of_done_b:
    s_mov_b64 exec, -1
    s_mov_b32 s56, 0
    s_cbranch_scc1 L_po_far
    buffer_load_dword v2, v3, s[40:43], s72 offen sc1
    s_nop 15
L_po:
    buffer_load_dword v4, v3, s[40:43], s72 offen sc1
    s_waitcnt vmcnt(1)
    v_cmp_eq_u32 vcc, 0, v2
    s_add_u32 s56, s56, 1
    s_cbranch_vccz L_pod
    buffer_load_dword v2, v3, s[40:43], s72 offen sc1
    s_waitcnt vmcnt(1)
    v_cmp_eq_u32 vcc, 0, v4
    s_cmp_lt_u32 s56, 200000
    s_cbranch_vccz L_pod
    s_cbranch_scc1 L_po
L_pod:
    s_add_u32 m0, s69, 0
    s_add_u32 s30, s68, 0
    buffer_load_dwordx4 v167, s[40:43], s30 offen sc1 lds
    s_add_u32 m0, s69, 32768
    s_add_u32 s30, s68, 32768
    buffer_load_dwordx4 v167, s[40:43], s30 offen sc1 lds
    s_add_u32 m0, s69, 4096
    s_add_u32 s30, s68, 4096
    buffer_load_dwordx4 v167, s[40:43], s30 offen sc1 lds
    s_add_u32 m0, s69, 36864
    s_add_u32 s30, s68, 36864
    buffer_load_dwordx4 v167, s[40:43], s30 offen sc1 lds
    s_add_u32 m0, s69, 8192
    s_add_u32 s30, s68, 8192
    buffer_load_dwordx4 v167, s[40:43], s30 offen sc1 lds
    s_add_u32 m0, s69, 40960
    s_add_u32 s30, s68, 40960
    buffer_load_dwordx4 v167, s[40:43], s30 offen sc1 lds
    s_add_u32 m0, s69, 12288
    s_add_u32 s30, s68, 12288
    buffer_load_dwordx4 v167, s[40:43], s30 offen sc1 lds
    s_add_u32 m0, s69, 45056
    s_add_u32 s30, s68, 45056
    buffer_load_dwordx4 v167, s[40:43], s30 offen sc1 lds
    s_waitcnt vmcnt(6)
    s_barrier
    s_add_u32 m0, s69, 16384
    s_add_u32 s30, s68, 16384
    buffer_load_dwordx4 v167, s[40:43], s30 offen sc1 lds
    s_add_u32 m0, s69, 49152
    s_add_u32 s30, s68, 49152
    buffer_load_dwordx4 v167, s[40:43], s30 offen sc1 lds
    s_waitcnt vmcnt(6)
    s_barrier
    s_add_u32 m0, s69, 20480
    s_add_u32 s30, s68, 20480
    buffer_load_dwordx4 v167, s[40:43], s30 offen sc1 lds
    s_add_u32 m0, s69, 53248
    s_add_u32 s30, s68, 53248
    buffer_load_dwordx4 v167, s[40:43], s30 offen sc1 lds
    s_waitcnt vmcnt(6)
    s_barrier
    s_add_u32 m0, s69, 24576
    s_add_u32 s30, s68, 24576
    buffer_load_dwordx4 v167, s[40:43], s30 offen sc1 lds
    s_add_u32 m0, s69, 57344
    s_add_u32 s30, s68, 57344
    buffer_load_dwordx4 v167, s[40:43], s30 offen sc1 lds
    s_waitcnt vmcnt(6)
    s_barrier
    s_add_u32 m0, s69, 28672
    s_add_u32 s30, s68, 28672
    buffer_load_dwordx4 v167, s[40:43], s30 offen sc1 lds
    s_add_u32 m0, s69, 61440
    s_add_u32 s30, s68, 61440
    buffer_load_dwordx4 v167, s[40:43], s30 offen sc1 lds
    s_waitcnt vmcnt(6)
    s_barrier
    s_waitcnt vmcnt(4)
    s_barrier
    s_waitcnt vmcnt(2)
    s_barrier
    s_waitcnt vmcnt(0)
    s_barrier
    s_endpgm
L_po_far:
    s_sleep 32
    buffer_load_dword v2, v3, s[40:43], s72 offen sc1
    s_add_u32 s56, s56, 1
    s_waitcnt vmcnt(0)
    v_cmp_eq_u32 vcc, 0, v2
    s_cmp_lt_u32 s56, 200000
    s_cbranch_vccz L_pod
    s_cbranch_scc1 L_po_far
    s_branch L_pod
L_b_sq:
    ds_read_b32 v149, v160 offset:4
    ds_read_b128 v[140:143], v161
    ds_read_b64 v[162:163], v164
    s_add_u32 s56, s56, 1
    s_waitcnt lgkmcnt(0)
    v_readfirstlane_b32 s30, v149
    s_cmp_ge_u32 s56, 200000
    s_cbranch_scc1 L_b_sqd
    s_cmp_lt_u32 s30, 8
    s_cbranch_scc1 L_b_sq
    s_branch L_b_sqd
L_ost_far:
    buffer_store_dwordx4 v[156:159], v167, s[40:43], s67 offen sc1
    s_branch L_ost_done
.fill ((1744 - (. - recurrent_scan__softmax_full_mha__moe_arch_mod__prompt_kernel)) & 0xfff) >> 2, 4, 0xbf800000
L_compute:
    v_mov_b32 v166, v0
    v_lshlrev_b32 v167, 4, v0
    v_mov_b32 v4, s48
    s_lshr_b32 s58, s5, 3
    s_mov_b32 s62, 0xffff
    s_mov_b32 s63, 0xffff
    s_lshl_b32 s64, s3, 1
    s_add_u32 s64, s64, s58
    s_lshl_b32 s64, s64, 17
    s_or_b32 s61, s4, 1
    s_add_u32 s61, s61, 1
    s_lshl_b32 s61, s61, 13
    s_lshl_b32 s31, s6, 11
    s_add_u32 s61, s61, s31
    s_mov_b32 s76, 0
    s_mov_b32 s77, 0
    s_lshl_b32 s31, s58, 12
    s_add_u32 s30, s6, 1
    s_and_b32 s30, s30, 3
    s_lshl_b32 s30, s30, 10
    s_add_u32 s72, s30, s31
    s_add_u32 s30, s6, 2
    s_and_b32 s30, s30, 3
    s_lshl_b32 s30, s30, 10
    s_add_u32 s73, s30, s31
    s_add_u32 s30, s6, 3
    s_and_b32 s30, s30, 3
    s_lshl_b32 s30, s30, 10
    s_add_u32 s74, s30, s31
    s_add_u32 s30, s6, 4
    s_and_b32 s30, s30, 3
    s_lshl_b32 s30, s30, 10
    s_add_u32 s75, s30, s31
    s_waitcnt lgkmcnt(0)
    s_mov_b32 s40, s28
    s_mov_b32 s41, s29
    s_mov_b32 s42, 268435456
    s_mov_b32 s43, 0x20000
    s_cmp_ge_u32 s5, 8
    s_cbranch_scc1 L_bwave
    v_and_b32 v1, 15, v0
    v_lshrrev_b32 v2, 4, v0
    v_lshrrev_b32 v3, 1, v1
    v_xor_b32 v3, v3, v2
    s_lshl_b32 s30, s6, 12
    s_add_u32 s30, s30, 65536
    v_lshl_add_u32 v5, v1, 7, s30
    v_lshl_add_u32 v144, v3, 4, v5
    v_xor_b32 v145, 64, v144
    v_add_u32 v146, 65536, v144
    v_add_u32 v147, 65536, v145
    v_bfe_u32 v3, v0, 2, 2
    v_lshl_add_u32 v5, v2, 3, v3
    v_and_b32 v6, 3, v0
    v_lshlrev_b32 v7, 3, v6
    v_lshl_add_u32 v5, v5, 7, v7
    v_bfe_u32 v3, v0, 3, 2
    s_lshl_b32 s30, s6, 7
    s_add_u32 s30, s30, 160000
    v_lshl_add_u32 v156, v1, 3, s30
    v_lshl_add_u32 v158, v2, 8, v156
    v_lshlrev_b32 v7, 4, v2
    v_lshl_add_u32 v7, v6, 7, v7
    v_add_u32 v153, 155520, v7
    s_lshr_b32 s49, s3, 1
    s_lshl_b32 s49, s49, 19
    s_lshl_b32 s30, s4, 13
    s_add_u32 s49, s49, s30
    s_lshl_b32 s30, s6, 11
    s_add_u32 s49, s49, s30
    s_and_b32 s30, s3, 1
    s_lshl_b32 s30, s30, 10
    s_add_u32 s49, s49, s30
    s_add_u32 s30, s6, 0
    s_and_b32 s30, s30, 3
    v_xor_b32 v7, s30, v3
    v_lshl_add_u32 v148, v7, 5, v5
    s_lshl_b32 s30, s30, 17
    s_add_u32 s50, s30, s49
    s_add_u32 s30, s6, 1
    s_and_b32 s30, s30, 3
    v_xor_b32 v7, s30, v3
    v_lshl_add_u32 v149, v7, 5, v5
    s_lshl_b32 s30, s30, 17
    s_add_u32 s51, s30, s49
    s_add_u32 s30, s6, 2
    s_and_b32 s30, s30, 3
    v_xor_b32 v7, s30, v3
    v_lshl_add_u32 v150, v7, 5, v5
    s_lshl_b32 s30, s30, 17
    s_add_u32 s57, s30, s49
    s_add_u32 s30, s6, 3
    s_and_b32 s30, s30, 3
    v_xor_b32 v7, s30, v3
    v_lshl_add_u32 v151, v7, 5, v5
    s_lshl_b32 s30, s30, 17
    s_add_u32 s59, s30, s49
    s_mov_b32 s52, 0x01010101
    s_mov_b32 s53, 0x01010101
    s_mov_b32 s54, 0x10101010
    s_mov_b32 s55, 0x10101010
    s_cmp_eq_u32 s3, s4
    s_cselect_b32 s68, 0x0e0e0e0e, 0
    s_mov_b32 s69, s68
    s_lshl_b64 s[78:79], s[68:69], 4
    v_cndmask_b32 v96, 0, v4, s[52:53]
    v_cndmask_b32 v97, 0, v4, s[52:53]
    v_cndmask_b32 v98, 0, v4, s[52:53]
    v_cndmask_b32 v99, 0, v4, s[52:53]
    v_cndmask_b32 v100, 0, v4, s[54:55]
    v_cndmask_b32 v101, 0, v4, s[54:55]
    v_cndmask_b32 v102, 0, v4, s[54:55]
    v_cndmask_b32 v103, 0, v4, s[54:55]
    v_cndmask_b32 v104, 0, v4, s[52:53]
    v_cndmask_b32 v105, 0, v4, s[52:53]
    v_cndmask_b32 v106, 0, v4, s[52:53]
    v_cndmask_b32 v107, 0, v4, s[52:53]
    v_cndmask_b32 v108, 0, v4, s[54:55]
    v_cndmask_b32 v109, 0, v4, s[54:55]
    v_cndmask_b32 v110, 0, v4, s[54:55]
    v_cndmask_b32 v111, 0, v4, s[54:55]
    v_and_b32 v1, 31, v166
    s_lshl_b32 s30, s6, 5
    v_add_lshl_u32 v152, v1, s30, 3
    v_add_u32 v152, 157952, v152
    v_add_u32 v5, 155648, v167
    v_mov_b32 v8, v4
    v_mov_b32 v9, v4
    v_mov_b32 v10, v4
    v_mov_b32 v11, v4
    s_mov_b32 s52, 0xaaaaaaaa
    s_mov_b32 s53, 0xaaaaaaaa
    s_mov_b32 s54, 0xcccccccc
    s_mov_b32 s55, 0xcccccccc
    v_and_b32 v6, 27, v166
    v_cmp_eq_u32 vcc, 16, v6
    v_mov_b32 v6, s48
    s_nop 0
    v_cndmask_b32_e64 v154, 0, v6, vcc
    v_cndmask_b32_e64 v155, 0, v6, vcc
    v_cmp_gt_u32 vcc, 16, v166
    s_bitcmp1_b32 s3, 0
    s_cbranch_scc1 L_a_v
    s_barrier
    ds_read_b128 v[12:15], v5
    ds_read_b64_tr_b16 v[32:33], v148 offset:0
    ds_read_b64_tr_b16 v[34:35], v148 offset:512
    ds_read_b64_tr_b16 v[36:37], v149 offset:0
    ds_read_b64_tr_b16 v[38:39], v149 offset:512
    ds_read_b64_tr_b16 v[40:41], v150 offset:0
    ds_read_b64_tr_b16 v[42:43], v150 offset:512
    ds_read_b64_tr_b16 v[44:45], v151 offset:0
    ds_read_b64_tr_b16 v[46:47], v151 offset:512
    s_waitcnt lgkmcnt(8)
    v_mfma_f32_16x16x32_bf16 v[16:19], v[8:11], v[12:15], 0
    s_nop 7
    v_add_f32_dpp v16, v16, v16 row_ror:8 row_mask:0xf bank_mask:0xf
    s_nop 1
    v_add_f32_dpp v16, v16, v16 row_ror:4 row_mask:0xf bank_mask:0xf
    s_nop 1
    v_add_f32_dpp v16, v16, v16 row_ror:2 row_mask:0xf bank_mask:0xf
    s_nop 1
    v_add_f32_dpp v16, v16, v16 row_ror:1 row_mask:0xf bank_mask:0xf
    s_nop 0
    v_readfirstlane_b32 s70, v16
    s_mov_b64 exec, s[68:69]
    ds_read_b128 v[96:99], v153 offset:0
    ds_read_b128 v[104:107], v153 offset:64
    s_mov_b64 exec, s[78:79]
    ds_read_b128 v[100:103], v153 offset:0
    ds_read_b128 v[108:111], v153 offset:64
    s_mov_b64 exec, -1
    s_waitcnt lgkmcnt(0)
    s_barrier
    ds_read_b128 v[0:3], v144 offset:0
    ds_read_b128 v[4:7], v144 offset:2048
    s_waitcnt lgkmcnt(1)
    v_mfma_f32_16x16x32_bf16 v[64:67], v[32:35], v[0:3], 0
    ds_read_b128 v[8:11], v145 offset:0
    ds_read_b128 v[12:15], v145 offset:2048
    s_waitcnt lgkmcnt(2)
    v_mfma_f32_16x16x32_bf16 v[80:83], v[32:35], v[4:7], 0
    ds_read_b64_tr_b16 v[48:49], v148 offset:4096
    ds_read_b64_tr_b16 v[50:51], v148 offset:4608
    v_mfma_f32_16x16x32_bf16 v[140:143], v[96:99], v[32:35], 0
    ds_read_b64_tr_b16 v[52:53], v149 offset:4096
    ds_read_b64_tr_b16 v[54:55], v149 offset:4608
    v_mfma_f32_16x16x32_bf16 v[68:71], v[36:39], v[0:3], 0
    ds_read_b64_tr_b16 v[56:57], v150 offset:4096
    ds_read_b64_tr_b16 v[58:59], v150 offset:4608
    v_mfma_f32_16x16x32_bf16 v[84:87], v[36:39], v[4:7], 0
    ds_read_b64_tr_b16 v[60:61], v151 offset:4096
    ds_read_b64_tr_b16 v[62:63], v151 offset:4608
    v_mfma_f32_16x16x32_bf16 v[72:75], v[40:43], v[0:3], 0
    ds_read_b64_tr_b16 v[32:33], v148 offset:8192
    ds_read_b64_tr_b16 v[34:35], v148 offset:8704
    v_mfma_f32_16x16x32_bf16 v[88:91], v[40:43], v[4:7], 0
    ds_read_b64_tr_b16 v[36:37], v149 offset:8192
    ds_read_b64_tr_b16 v[38:39], v149 offset:8704
    v_mfma_f32_16x16x32_bf16 v[76:79], v[44:47], v[0:3], 0
    ds_read_b64_tr_b16 v[40:41], v150 offset:8192
    s_waitcnt lgkmcnt(9)
    ds_read_b64_tr_b16 v[42:43], v150 offset:8704
    v_mfma_f32_16x16x32_bf16 v[92:95], v[44:47], v[4:7], 0
    v_mfma_f32_16x16x32_bf16 v[116:119], v[96:99], v[0:3], 0
    ds_read_b64_tr_b16 v[44:45], v151 offset:8192
    ds_read_b64_tr_b16 v[46:47], v151 offset:8704
    v_mfma_f32_16x16x32_bf16 v[116:119], v[100:103], v[4:7], v[116:119]
    v_mfma_f32_16x16x32_bf16 v[116:119], v[104:107], v[8:11], v[116:119]
    v_mfma_f32_16x16x32_bf16 v[116:119], v[108:111], v[12:15], v[116:119]
    v_mfma_f32_4x4x4_16b_bf16 v[124:127], v[0:1], v[0:1], 0
    v_mfma_f32_4x4x4_16b_bf16 v[128:131], v[2:3], v[2:3], 0
    v_mfma_f32_4x4x4_16b_bf16 v[132:135], v[4:5], v[4:5], 0
    v_mfma_f32_4x4x4_16b_bf16 v[136:139], v[6:7], v[6:7], 0
    v_mfma_f32_4x4x4_16b_bf16 v[124:127], v[8:9], v[8:9], v[124:127]
    v_mfma_f32_4x4x4_16b_bf16 v[128:131], v[10:11], v[10:11], v[128:131]
    v_mfma_f32_4x4x4_16b_bf16 v[132:135], v[12:13], v[12:13], v[132:135]
    v_mfma_f32_4x4x4_16b_bf16 v[136:139], v[14:15], v[14:15], v[136:139]
    s_barrier
    ds_read_b128 v[16:19], v144 offset:16384
    ds_read_b128 v[20:23], v144 offset:18432
    v_mfma_f32_16x16x32_bf16 v[64:67], v[48:51], v[8:11], v[64:67]
    ds_read_b128 v[24:27], v145 offset:16384
    s_waitcnt lgkmcnt(9)
    ds_read_b128 v[28:31], v145 offset:18432
    v_mfma_f32_16x16x32_bf16 v[80:83], v[48:51], v[12:15], v[80:83]
    v_mfma_f32_16x16x32_bf16 v[140:143], v[96:99], v[48:51], v[140:143]
    v_mfma_f32_16x16x32_bf16 v[68:71], v[52:55], v[8:11], v[68:71]
    ds_read_b64_tr_b16 v[48:49], v148 offset:12288
    ds_read_b64_tr_b16 v[50:51], v148 offset:12800
    v_mfma_f32_16x16x32_bf16 v[84:87], v[52:55], v[12:15], v[84:87]
    v_mfma_f32_16x16x32_bf16 v[72:75], v[56:59], v[8:11], v[72:75]
    ds_read_b64_tr_b16 v[52:53], v149 offset:12288
    ds_read_b64_tr_b16 v[54:55], v149 offset:12800
    v_mfma_f32_16x16x32_bf16 v[88:91], v[56:59], v[12:15], v[88:91]
    v_mfma_f32_16x16x32_bf16 v[76:79], v[60:63], v[8:11], v[76:79]
    ds_read_b64_tr_b16 v[56:57], v150 offset:12288
    s_waitcnt lgkmcnt(9)
    ds_read_b64_tr_b16 v[58:59], v150 offset:12800
    v_mfma_f32_16x16x32_bf16 v[92:95], v[60:63], v[12:15], v[92:95]
    s_waitcnt lgkmcnt(9)
    v_mfma_f32_16x16x32_bf16 v[64:67], v[32:35], v[16:19], v[64:67]
    ds_read_b64_tr_b16 v[60:61], v151 offset:12288
    ds_read_b64_tr_b16 v[62:63], v151 offset:12800
    s_waitcnt lgkmcnt(10)
    v_mfma_f32_16x16x32_bf16 v[80:83], v[32:35], v[20:23], v[80:83]
    v_mfma_f32_16x16x32_bf16 v[140:143], v[96:99], v[32:35], v[140:143]
    v_mfma_f32_16x16x32_bf16 v[68:71], v[36:39], v[16:19], v[68:71]
    ds_read_b64_tr_b16 v[32:33], v148 offset:16384
    ds_read_b64_tr_b16 v[34:35], v148 offset:16896
    v_mfma_f32_16x16x32_bf16 v[84:87], v[36:39], v[20:23], v[84:87]
    v_mfma_f32_16x16x32_bf16 v[72:75], v[40:43], v[16:19], v[72:75]
    ds_read_b64_tr_b16 v[36:37], v149 offset:16384
    ds_read_b64_tr_b16 v[38:39], v149 offset:16896
    v_mfma_f32_16x16x32_bf16 v[88:91], v[40:43], v[20:23], v[88:91]
    v_mfma_f32_16x16x32_bf16 v[76:79], v[44:47], v[16:19], v[76:79]
    ds_read_b64_tr_b16 v[40:41], v150 offset:16384
    s_waitcnt lgkmcnt(9)
    ds_read_b64_tr_b16 v[42:43], v150 offset:16896
    v_mfma_f32_16x16x32_bf16 v[92:95], v[44:47], v[20:23], v[92:95]
    v_mfma_f32_16x16x32_bf16 v[112:115], v[96:99], v[16:19], 0
    ds_read_b64_tr_b16 v[44:45], v151 offset:16384
    ds_read_b64_tr_b16 v[46:47], v151 offset:16896
    v_mfma_f32_16x16x32_bf16 v[112:115], v[100:103], v[20:23], v[112:115]
    v_mfma_f32_16x16x32_bf16 v[112:115], v[104:107], v[24:27], v[112:115]
    v_mfma_f32_16x16x32_bf16 v[112:115], v[108:111], v[28:31], v[112:115]
    v_mfma_f32_4x4x4_16b_bf16 v[124:127], v[16:17], v[16:17], v[124:127]
    v_mfma_f32_4x4x4_16b_bf16 v[128:131], v[18:19], v[18:19], v[128:131]
    v_mfma_f32_4x4x4_16b_bf16 v[132:135], v[20:21], v[20:21], v[132:135]
    v_mfma_f32_4x4x4_16b_bf16 v[136:139], v[22:23], v[22:23], v[136:139]
    v_mfma_f32_4x4x4_16b_bf16 v[124:127], v[24:25], v[24:25], v[124:127]
    v_mfma_f32_4x4x4_16b_bf16 v[128:131], v[26:27], v[26:27], v[128:131]
    v_mfma_f32_4x4x4_16b_bf16 v[132:135], v[28:29], v[28:29], v[132:135]
    v_mfma_f32_4x4x4_16b_bf16 v[136:139], v[30:31], v[30:31], v[136:139]
    s_barrier
    ds_read_b128 v[0:3], v144 offset:32768
    ds_read_b128 v[4:7], v144 offset:34816
    v_mfma_f32_16x16x32_bf16 v[64:67], v[48:51], v[24:27], v[64:67]
    ds_read_b128 v[8:11], v145 offset:32768
    s_waitcnt lgkmcnt(9)
    ds_read_b128 v[12:15], v145 offset:34816
    v_mfma_f32_16x16x32_bf16 v[80:83], v[48:51], v[28:31], v[80:83]
    v_mfma_f32_16x16x32_bf16 v[140:143], v[96:99], v[48:51], v[140:143]
    v_mfma_f32_16x16x32_bf16 v[68:71], v[52:55], v[24:27], v[68:71]
    ds_read_b64_tr_b16 v[48:49], v148 offset:20480
    ds_read_b64_tr_b16 v[50:51], v148 offset:20992
    v_mfma_f32_16x16x32_bf16 v[84:87], v[52:55], v[28:31], v[84:87]
    v_mfma_f32_16x16x32_bf16 v[72:75], v[56:59], v[24:27], v[72:75]
    ds_read_b64_tr_b16 v[52:53], v149 offset:20480
    ds_read_b64_tr_b16 v[54:55], v149 offset:20992
    v_mfma_f32_16x16x32_bf16 v[88:91], v[56:59], v[28:31], v[88:91]
    v_mfma_f32_16x16x32_bf16 v[76:79], v[60:63], v[24:27], v[76:79]
    ds_read_b64_tr_b16 v[56:57], v150 offset:20480
    s_waitcnt lgkmcnt(9)
    ds_read_b64_tr_b16 v[58:59], v150 offset:20992
    v_mfma_f32_16x16x32_bf16 v[92:95], v[60:63], v[28:31], v[92:95]
    s_waitcnt lgkmcnt(9)
    v_mfma_f32_16x16x32_bf16 v[64:67], v[32:35], v[0:3], v[64:67]
    ds_read_b64_tr_b16 v[60:61], v151 offset:20480
    ds_read_b64_tr_b16 v[62:63], v151 offset:20992
    s_waitcnt lgkmcnt(10)
    v_mfma_f32_16x16x32_bf16 v[80:83], v[32:35], v[4:7], v[80:83]
    v_mfma_f32_16x16x32_bf16 v[140:143], v[96:99], v[32:35], v[140:143]
    v_mfma_f32_16x16x32_bf16 v[68:71], v[36:39], v[0:3], v[68:71]
    ds_read_b64_tr_b16 v[32:33], v148 offset:24576
    ds_read_b64_tr_b16 v[34:35], v148 offset:25088
    v_mfma_f32_16x16x32_bf16 v[84:87], v[36:39], v[4:7], v[84:87]
    v_mfma_f32_16x16x32_bf16 v[72:75], v[40:43], v[0:3], v[72:75]
    ds_read_b64_tr_b16 v[36:37], v149 offset:24576
    ds_read_b64_tr_b16 v[38:39], v149 offset:25088
    v_mfma_f32_16x16x32_bf16 v[88:91], v[40:43], v[4:7], v[88:91]
    v_mfma_f32_16x16x32_bf16 v[76:79], v[44:47], v[0:3], v[76:79]
    ds_read_b64_tr_b16 v[40:41], v150 offset:24576
    s_waitcnt lgkmcnt(9)
    ds_read_b64_tr_b16 v[42:43], v150 offset:25088
    v_mfma_f32_16x16x32_bf16 v[92:95], v[44:47], v[4:7], v[92:95]
    v_mfma_f32_16x16x32_bf16 v[120:123], v[96:99], v[0:3], 0
    ds_read_b64_tr_b16 v[44:45], v151 offset:24576
    ds_read_b64_tr_b16 v[46:47], v151 offset:25088
    v_mfma_f32_16x16x32_bf16 v[120:123], v[100:103], v[4:7], v[120:123]
    v_mfma_f32_16x16x32_bf16 v[120:123], v[104:107], v[8:11], v[120:123]
    v_mfma_f32_16x16x32_bf16 v[120:123], v[108:111], v[12:15], v[120:123]
    v_mfma_f32_4x4x4_16b_bf16 v[124:127], v[0:1], v[0:1], v[124:127]
    v_mfma_f32_4x4x4_16b_bf16 v[128:131], v[2:3], v[2:3], v[128:131]
    v_mfma_f32_4x4x4_16b_bf16 v[132:135], v[4:5], v[4:5], v[132:135]
    v_mfma_f32_4x4x4_16b_bf16 v[136:139], v[6:7], v[6:7], v[136:139]
    v_mfma_f32_4x4x4_16b_bf16 v[124:127], v[8:9], v[8:9], v[124:127]
    v_mfma_f32_4x4x4_16b_bf16 v[128:131], v[10:11], v[10:11], v[128:131]
    v_mfma_f32_4x4x4_16b_bf16 v[132:135], v[12:13], v[12:13], v[132:135]
    v_mfma_f32_4x4x4_16b_bf16 v[136:139], v[14:15], v[14:15], v[136:139]
    s_mov_b64 exec, s[68:69]
    ds_read_b128 v[96:99], v153 offset:384
    ds_read_b128 v[104:107], v153 offset:448
    s_mov_b64 exec, s[78:79]
    ds_read_b128 v[100:103], v153 offset:384
    s_waitcnt lgkmcnt(9)
    ds_read_b128 v[108:111], v153 offset:448
    s_mov_b64 exec, -1
    s_barrier
    ds_read_b128 v[16:19], v144 offset:49152
    ds_read_b128 v[20:23], v144 offset:51200
    v_mfma_f32_16x16x32_bf16 v[64:67], v[48:51], v[8:11], v[64:67]
    ds_read_b128 v[24:27], v145 offset:49152
    ds_read_b128 v[28:31], v145 offset:51200
    v_mfma_f32_16x16x32_bf16 v[80:83], v[48:51], v[12:15], v[80:83]
    v_mfma_f32_16x16x32_bf16 v[140:143], v[96:99], v[48:51], v[140:143]
    v_mfma_f32_16x16x32_bf16 v[68:71], v[52:55], v[8:11], v[68:71]
    ds_read_b64_tr_b16 v[48:49], v148 offset:28672
    s_waitcnt lgkmcnt(9)
    ds_read_b64_tr_b16 v[50:51], v148 offset:29184
    v_mfma_f32_16x16x32_bf16 v[84:87], v[52:55], v[12:15], v[84:87]
    v_mfma_f32_16x16x32_bf16 v[72:75], v[56:59], v[8:11], v[72:75]
    ds_read_b64_tr_b16 v[52:53], v149 offset:28672
    ds_read_b64_tr_b16 v[54:55], v149 offset:29184
    v_mfma_f32_16x16x32_bf16 v[88:91], v[56:59], v[12:15], v[88:91]
    v_mfma_f32_16x16x32_bf16 v[76:79], v[60:63], v[8:11], v[76:79]
    ds_read_b64_tr_b16 v[56:57], v150 offset:28672
    ds_read_b64_tr_b16 v[58:59], v150 offset:29184
    v_mfma_f32_16x16x32_bf16 v[92:95], v[60:63], v[12:15], v[92:95]
    s_waitcnt lgkmcnt(9)
    v_mfma_f32_16x16x32_bf16 v[64:67], v[32:35], v[16:19], v[64:67]
    ds_read_b64_tr_b16 v[60:61], v151 offset:28672
    ds_read_b64_tr_b16 v[62:63], v151 offset:29184
    s_waitcnt lgkmcnt(10)
    v_mfma_f32_16x16x32_bf16 v[80:83], v[32:35], v[20:23], v[80:83]
    v_mfma_f32_16x16x32_bf16 v[140:143], v[96:99], v[32:35], v[140:143]
    v_mfma_f32_16x16x32_bf16 v[68:71], v[36:39], v[16:19], v[68:71]
    ds_read_b64_tr_b16 v[32:33], v148 offset:32768
    ds_read_b64_tr_b16 v[34:35], v148 offset:33280
    v_mfma_f32_16x16x32_bf16 v[84:87], v[36:39], v[20:23], v[84:87]
    v_mfma_f32_16x16x32_bf16 v[72:75], v[40:43], v[16:19], v[72:75]
    ds_read_b64_tr_b16 v[36:37], v149 offset:32768
    ds_read_b64_tr_b16 v[38:39], v149 offset:33280
    v_mfma_f32_16x16x32_bf16 v[88:91], v[40:43], v[20:23], v[88:91]
    v_mfma_f32_16x16x32_bf16 v[76:79], v[44:47], v[16:19], v[76:79]
    ds_read_b64_tr_b16 v[40:41], v150 offset:32768
    s_waitcnt lgkmcnt(9)
    ds_read_b64_tr_b16 v[42:43], v150 offset:33280
    v_mfma_f32_16x16x32_bf16 v[92:95], v[44:47], v[20:23], v[92:95]
    v_mfma_f32_16x16x32_bf16 v[116:119], v[96:99], v[16:19], v[116:119]
    ds_read_b64_tr_b16 v[44:45], v151 offset:32768
    ds_read_b64_tr_b16 v[46:47], v151 offset:33280
    v_mfma_f32_16x16x32_bf16 v[116:119], v[100:103], v[20:23], v[116:119]
    v_mfma_f32_16x16x32_bf16 v[116:119], v[104:107], v[24:27], v[116:119]
    v_mfma_f32_16x16x32_bf16 v[116:119], v[108:111], v[28:31], v[116:119]
    v_mfma_f32_4x4x4_16b_bf16 v[124:127], v[16:17], v[16:17], v[124:127]
    v_mfma_f32_4x4x4_16b_bf16 v[128:131], v[18:19], v[18:19], v[128:131]
    v_mfma_f32_4x4x4_16b_bf16 v[132:135], v[20:21], v[20:21], v[132:135]
    v_mfma_f32_4x4x4_16b_bf16 v[136:139], v[22:23], v[22:23], v[136:139]
    v_mfma_f32_4x4x4_16b_bf16 v[124:127], v[24:25], v[24:25], v[124:127]
    v_mfma_f32_4x4x4_16b_bf16 v[128:131], v[26:27], v[26:27], v[128:131]
    v_mfma_f32_4x4x4_16b_bf16 v[132:135], v[28:29], v[28:29], v[132:135]
    v_mfma_f32_4x4x4_16b_bf16 v[136:139], v[30:31], v[30:31], v[136:139]
    s_barrier
    ds_read_b128 v[0:3], v146 offset:0
    ds_read_b128 v[4:7], v146 offset:2048
    v_mfma_f32_16x16x32_bf16 v[64:67], v[48:51], v[24:27], v[64:67]
    ds_read_b128 v[8:11], v147 offset:0
    s_waitcnt lgkmcnt(9)
    ds_read_b128 v[12:15], v147 offset:2048
    v_mfma_f32_16x16x32_bf16 v[80:83], v[48:51], v[28:31], v[80:83]
    v_mfma_f32_16x16x32_bf16 v[140:143], v[96:99], v[48:51], v[140:143]
    v_mfma_f32_16x16x32_bf16 v[68:71], v[52:55], v[24:27], v[68:71]
    ds_read_b64_tr_b16 v[48:49], v148 offset:36864
    ds_read_b64_tr_b16 v[50:51], v148 offset:37376
    v_mfma_f32_16x16x32_bf16 v[84:87], v[52:55], v[28:31], v[84:87]
    v_mfma_f32_16x16x32_bf16 v[72:75], v[56:59], v[24:27], v[72:75]
    ds_read_b64_tr_b16 v[52:53], v149 offset:36864
    ds_read_b64_tr_b16 v[54:55], v149 offset:37376
    v_mfma_f32_16x16x32_bf16 v[88:91], v[56:59], v[28:31], v[88:91]
    v_mfma_f32_16x16x32_bf16 v[76:79], v[60:63], v[24:27], v[76:79]
    ds_read_b64_tr_b16 v[56:57], v150 offset:36864
    s_waitcnt lgkmcnt(9)
    ds_read_b64_tr_b16 v[58:59], v150 offset:37376
    v_mfma_f32_16x16x32_bf16 v[92:95], v[60:63], v[28:31], v[92:95]
    s_waitcnt lgkmcnt(9)
    v_mfma_f32_16x16x32_bf16 v[64:67], v[32:35], v[0:3], v[64:67]
    ds_read_b64_tr_b16 v[60:61], v151 offset:36864
    ds_read_b64_tr_b16 v[62:63], v151 offset:37376
    s_waitcnt lgkmcnt(10)
    v_mfma_f32_16x16x32_bf16 v[80:83], v[32:35], v[4:7], v[80:83]
    v_mfma_f32_16x16x32_bf16 v[140:143], v[96:99], v[32:35], v[140:143]
    v_mfma_f32_16x16x32_bf16 v[68:71], v[36:39], v[0:3], v[68:71]
    ds_read_b64_tr_b16 v[32:33], v148 offset:40960
    ds_read_b64_tr_b16 v[34:35], v148 offset:41472
    v_mfma_f32_16x16x32_bf16 v[84:87], v[36:39], v[4:7], v[84:87]
    v_mfma_f32_16x16x32_bf16 v[72:75], v[40:43], v[0:3], v[72:75]
    ds_read_b64_tr_b16 v[36:37], v149 offset:40960
    ds_read_b64_tr_b16 v[38:39], v149 offset:41472
    v_mfma_f32_16x16x32_bf16 v[88:91], v[40:43], v[4:7], v[88:91]
    v_mfma_f32_16x16x32_bf16 v[76:79], v[44:47], v[0:3], v[76:79]
    ds_read_b64_tr_b16 v[40:41], v150 offset:40960
    s_waitcnt lgkmcnt(9)
    ds_read_b64_tr_b16 v[42:43], v150 offset:41472
    v_mfma_f32_16x16x32_bf16 v[92:95], v[44:47], v[4:7], v[92:95]
    v_mfma_f32_16x16x32_bf16 v[112:115], v[96:99], v[0:3], v[112:115]
    ds_read_b64_tr_b16 v[44:45], v151 offset:40960
    ds_read_b64_tr_b16 v[46:47], v151 offset:41472
    v_mfma_f32_16x16x32_bf16 v[112:115], v[100:103], v[4:7], v[112:115]
    v_mfma_f32_16x16x32_bf16 v[112:115], v[104:107], v[8:11], v[112:115]
    v_mfma_f32_16x16x32_bf16 v[112:115], v[108:111], v[12:15], v[112:115]
    v_mfma_f32_4x4x4_16b_bf16 v[124:127], v[0:1], v[0:1], v[124:127]
    v_mfma_f32_4x4x4_16b_bf16 v[128:131], v[2:3], v[2:3], v[128:131]
    v_mfma_f32_4x4x4_16b_bf16 v[132:135], v[4:5], v[4:5], v[132:135]
    v_mfma_f32_4x4x4_16b_bf16 v[136:139], v[6:7], v[6:7], v[136:139]
    v_mfma_f32_4x4x4_16b_bf16 v[124:127], v[8:9], v[8:9], v[124:127]
    v_mfma_f32_4x4x4_16b_bf16 v[128:131], v[10:11], v[10:11], v[128:131]
    v_mfma_f32_4x4x4_16b_bf16 v[132:135], v[12:13], v[12:13], v[132:135]
    v_mfma_f32_4x4x4_16b_bf16 v[136:139], v[14:15], v[14:15], v[136:139]
    s_barrier
    ds_read_b128 v[16:19], v144 offset:0
    ds_read_b128 v[20:23], v144 offset:2048
    v_mfma_f32_16x16x32_bf16 v[64:67], v[48:51], v[8:11], v[64:67]
    ds_read_b128 v[24:27], v145 offset:0
    s_waitcnt lgkmcnt(9)
    ds_read_b128 v[28:31], v145 offset:2048
    v_mfma_f32_16x16x32_bf16 v[80:83], v[48:51], v[12:15], v[80:83]
    v_mfma_f32_16x16x32_bf16 v[140:143], v[96:99], v[48:51], v[140:143]
    v_mfma_f32_16x16x32_bf16 v[68:71], v[52:55], v[8:11], v[68:71]
    ds_read_b64_tr_b16 v[48:49], v148 offset:45056
    ds_read_b64_tr_b16 v[50:51], v148 offset:45568
    v_mfma_f32_16x16x32_bf16 v[84:87], v[52:55], v[12:15], v[84:87]
    v_mfma_f32_16x16x32_bf16 v[72:75], v[56:59], v[8:11], v[72:75]
    ds_read_b64_tr_b16 v[52:53], v149 offset:45056
    ds_read_b64_tr_b16 v[54:55], v149 offset:45568
    v_mfma_f32_16x16x32_bf16 v[88:91], v[56:59], v[12:15], v[88:91]
    v_mfma_f32_16x16x32_bf16 v[76:79], v[60:63], v[8:11], v[76:79]
    ds_read_b64_tr_b16 v[56:57], v150 offset:45056
    s_waitcnt lgkmcnt(9)
    ds_read_b64_tr_b16 v[58:59], v150 offset:45568
    v_mfma_f32_16x16x32_bf16 v[92:95], v[60:63], v[12:15], v[92:95]
    s_waitcnt lgkmcnt(9)
    v_mfma_f32_16x16x32_bf16 v[64:67], v[32:35], v[16:19], v[64:67]
    ds_read_b64_tr_b16 v[60:61], v151 offset:45056
    ds_read_b64_tr_b16 v[62:63], v151 offset:45568
    s_waitcnt lgkmcnt(10)
    v_mfma_f32_16x16x32_bf16 v[80:83], v[32:35], v[20:23], v[80:83]
    v_mfma_f32_16x16x32_bf16 v[140:143], v[96:99], v[32:35], v[140:143]
    v_mfma_f32_16x16x32_bf16 v[68:71], v[36:39], v[16:19], v[68:71]
    ds_read_b64_tr_b16 v[32:33], v148 offset:49152
    ds_read_b64_tr_b16 v[34:35], v148 offset:49664
    v_mfma_f32_16x16x32_bf16 v[84:87], v[36:39], v[20:23], v[84:87]
    v_mfma_f32_16x16x32_bf16 v[72:75], v[40:43], v[16:19], v[72:75]
    ds_read_b64_tr_b16 v[36:37], v149 offset:49152
    ds_read_b64_tr_b16 v[38:39], v149 offset:49664
    v_mfma_f32_16x16x32_bf16 v[88:91], v[40:43], v[20:23], v[88:91]
    v_mfma_f32_16x16x32_bf16 v[76:79], v[44:47], v[16:19], v[76:79]
    ds_read_b64_tr_b16 v[40:41], v150 offset:49152
    s_waitcnt lgkmcnt(9)
    ds_read_b64_tr_b16 v[42:43], v150 offset:49664
    v_mfma_f32_16x16x32_bf16 v[92:95], v[44:47], v[20:23], v[92:95]
    v_mfma_f32_16x16x32_bf16 v[120:123], v[96:99], v[16:19], v[120:123]
    ds_read_b64_tr_b16 v[44:45], v151 offset:49152
    ds_read_b64_tr_b16 v[46:47], v151 offset:49664
    v_mfma_f32_16x16x32_bf16 v[120:123], v[100:103], v[20:23], v[120:123]
    v_mfma_f32_16x16x32_bf16 v[120:123], v[104:107], v[24:27], v[120:123]
    v_mfma_f32_16x16x32_bf16 v[120:123], v[108:111], v[28:31], v[120:123]
    v_mfma_f32_4x4x4_16b_bf16 v[124:127], v[16:17], v[16:17], v[124:127]
    v_mfma_f32_4x4x4_16b_bf16 v[128:131], v[18:19], v[18:19], v[128:131]
    v_mfma_f32_4x4x4_16b_bf16 v[132:135], v[20:21], v[20:21], v[132:135]
    v_mfma_f32_4x4x4_16b_bf16 v[136:139], v[22:23], v[22:23], v[136:139]
    v_mfma_f32_4x4x4_16b_bf16 v[124:127], v[24:25], v[24:25], v[124:127]
    v_mfma_f32_4x4x4_16b_bf16 v[128:131], v[26:27], v[26:27], v[128:131]
    v_mfma_f32_4x4x4_16b_bf16 v[132:135], v[28:29], v[28:29], v[132:135]
    v_mfma_f32_4x4x4_16b_bf16 v[136:139], v[30:31], v[30:31], v[136:139]
    s_mov_b64 exec, s[68:69]
    ds_read_b128 v[96:99], v153 offset:768
    ds_read_b128 v[104:107], v153 offset:832
    s_mov_b64 exec, s[78:79]
    ds_read_b128 v[100:103], v153 offset:768
    s_waitcnt lgkmcnt(9)
    ds_read_b128 v[108:111], v153 offset:832
    s_mov_b64 exec, -1
    s_barrier
    ds_read_b128 v[0:3], v144 offset:16384
    ds_read_b128 v[4:7], v144 offset:18432
    v_mfma_f32_16x16x32_bf16 v[64:67], v[48:51], v[24:27], v[64:67]
    ds_read_b128 v[8:11], v145 offset:16384
    ds_read_b128 v[12:15], v145 offset:18432
    v_mfma_f32_16x16x32_bf16 v[80:83], v[48:51], v[28:31], v[80:83]
    v_mfma_f32_16x16x32_bf16 v[140:143], v[96:99], v[48:51], v[140:143]
    v_mfma_f32_16x16x32_bf16 v[68:71], v[52:55], v[24:27], v[68:71]
    ds_read_b64_tr_b16 v[48:49], v148 offset:53248
    s_waitcnt lgkmcnt(9)
    ds_read_b64_tr_b16 v[50:51], v148 offset:53760
    v_mfma_f32_16x16x32_bf16 v[84:87], v[52:55], v[28:31], v[84:87]
    v_mfma_f32_16x16x32_bf16 v[72:75], v[56:59], v[24:27], v[72:75]
    ds_read_b64_tr_b16 v[52:53], v149 offset:53248
    ds_read_b64_tr_b16 v[54:55], v149 offset:53760
    v_mfma_f32_16x16x32_bf16 v[88:91], v[56:59], v[28:31], v[88:91]
    v_mfma_f32_16x16x32_bf16 v[76:79], v[60:63], v[24:27], v[76:79]
    ds_read_b64_tr_b16 v[56:57], v150 offset:53248
    ds_read_b64_tr_b16 v[58:59], v150 offset:53760
    v_mfma_f32_16x16x32_bf16 v[92:95], v[60:63], v[28:31], v[92:95]
    s_waitcnt lgkmcnt(9)
    v_mfma_f32_16x16x32_bf16 v[64:67], v[32:35], v[0:3], v[64:67]
    ds_read_b64_tr_b16 v[60:61], v151 offset:53248
    ds_read_b64_tr_b16 v[62:63], v151 offset:53760
    s_waitcnt lgkmcnt(10)
    v_mfma_f32_16x16x32_bf16 v[80:83], v[32:35], v[4:7], v[80:83]
    v_mfma_f32_16x16x32_bf16 v[140:143], v[96:99], v[32:35], v[140:143]
    s_waitcnt lgkmcnt(6)
    v_mfma_f32_16x16x32_bf16 v[64:67], v[48:51], v[8:11], v[64:67]
    ds_read_b64_tr_b16 v[32:33], v148 offset:57344
    ds_read_b64_tr_b16 v[34:35], v148 offset:57856
    v_mfma_f32_16x16x32_bf16 v[80:83], v[48:51], v[12:15], v[80:83]
    v_mfma_f32_16x16x32_bf16 v[140:143], v[96:99], v[48:51], v[140:143]
    v_mfma_f32_16x16x32_bf16 v[68:71], v[36:39], v[0:3], v[68:71]
    ds_read_b64_tr_b16 v[48:49], v148 offset:61440
    ds_read_b64_tr_b16 v[50:51], v148 offset:61952
    v_mfma_f32_16x16x32_bf16 v[84:87], v[36:39], v[4:7], v[84:87]
    v_mfma_f32_16x16x32_bf16 v[72:75], v[40:43], v[0:3], v[72:75]
    ds_read_b64_tr_b16 v[36:37], v149 offset:57344
    ds_read_b64_tr_b16 v[38:39], v149 offset:57856
    v_mfma_f32_16x16x32_bf16 v[88:91], v[40:43], v[4:7], v[88:91]
    v_mfma_f32_16x16x32_bf16 v[76:79], v[44:47], v[0:3], v[76:79]
    ds_read_b64_tr_b16 v[40:41], v150 offset:57344
    ds_read_b64_tr_b16 v[42:43], v150 offset:57856
    v_mfma_f32_16x16x32_bf16 v[92:95], v[44:47], v[4:7], v[92:95]
    s_waitcnt lgkmcnt(6)
    v_mfma_f32_16x16x32_bf16 v[140:143], v[96:99], v[32:35], v[140:143]
    ds_read_b64_tr_b16 v[44:45], v151 offset:57344
    ds_read_b64_tr_b16 v[46:47], v151 offset:57856
    s_waitcnt lgkmcnt(6)
    v_mfma_f32_16x16x32_bf16 v[140:143], v[96:99], v[48:51], v[140:143]
    v_mfma_f32_16x16x32_bf16 v[68:71], v[52:55], v[8:11], v[68:71]
    v_mfma_f32_16x16x32_bf16 v[84:87], v[52:55], v[12:15], v[84:87]
    ds_read_b64_tr_b16 v[52:53], v149 offset:61440
    ds_read_b64_tr_b16 v[54:55], v149 offset:61952
    v_mfma_f32_16x16x32_bf16 v[116:119], v[96:99], v[0:3], v[116:119]
    s_nop 1
    s_nop 0
    v_and_b32 v160, 0xffff0000, v140
    v_mfma_f32_16x16x32_bf16 v[116:119], v[100:103], v[4:7], v[116:119]
    v_sub_f32 v161, v140, v160
    v_and_b32 v162, 0xffff0000, v161
    v_mfma_f32_16x16x32_bf16 v[116:119], v[104:107], v[8:11], v[116:119]
    v_sub_f32 v161, v161, v162
    v_lshrrev_b32 v160, 16, v160
    v_mfma_f32_16x16x32_bf16 v[116:119], v[108:111], v[12:15], v[116:119]
    v_or_b32 v160, v160, v162
    v_lshrrev_b32 v161, 16, v161
    s_mov_b64 exec, s[62:63]
    ds_write_b64 v158, v[160:161]
    s_mov_b64 exec, -1
    v_mfma_f32_4x4x4_16b_bf16 v[124:127], v[0:1], v[0:1], v[124:127]
    v_mfma_f32_4x4x4_16b_bf16 v[128:131], v[2:3], v[2:3], v[128:131]
    v_mfma_f32_4x4x4_16b_bf16 v[132:135], v[4:5], v[4:5], v[132:135]
    v_mfma_f32_4x4x4_16b_bf16 v[136:139], v[6:7], v[6:7], v[136:139]
    v_mfma_f32_4x4x4_16b_bf16 v[124:127], v[8:9], v[8:9], v[124:127]
    v_mfma_f32_4x4x4_16b_bf16 v[128:131], v[10:11], v[10:11], v[128:131]
    v_add_f32 v163, v116, v120
    v_mfma_f32_4x4x4_16b_bf16 v[132:135], v[12:13], v[12:13], v[132:135]
    v_add_f32 v157, v117, v123
    v_mfma_f32_4x4x4_16b_bf16 v[136:139], v[14:15], v[14:15], v[136:139]
    s_waitcnt lgkmcnt(0)
    s_barrier
    ds_read_b128 v[16:19], v144 offset:32768
    ds_read_b128 v[20:23], v144 offset:34816
    v_mfma_f32_16x16x32_bf16 v[72:75], v[56:59], v[8:11], v[72:75]
    ds_read_b128 v[24:27], v145 offset:32768
    ds_read_b128 v[28:31], v145 offset:34816
    v_mfma_f32_16x16x32_bf16 v[88:91], v[56:59], v[12:15], v[88:91]
    v_mfma_f32_16x16x32_bf16 v[76:79], v[60:63], v[8:11], v[76:79]
    ds_read_b64_tr_b16 v[56:57], v150 offset:61440
    ds_read_b64_tr_b16 v[58:59], v150 offset:61952
    v_mfma_f32_16x16x32_bf16 v[92:95], v[60:63], v[12:15], v[92:95]
    s_waitcnt lgkmcnt(2)
    v_mfma_f32_16x16x32_bf16 v[112:115], v[96:99], v[16:19], v[112:115]
    ds_read_b64_tr_b16 v[60:61], v151 offset:61440
    ds_read_b64_tr_b16 v[62:63], v151 offset:61952
    v_mfma_f32_16x16x32_bf16 v[112:115], v[100:103], v[20:23], v[112:115]
    ds_read_b64 v[116:117], v156 offset:0
    ds_read_b64 v[118:119], v156 offset:128
    v_mfma_f32_16x16x32_bf16 v[112:115], v[104:107], v[24:27], v[112:115]
    ds_read_b64 v[120:121], v156 offset:256
    ds_read_b64 v[122:123], v156 offset:384
    v_mfma_f32_16x16x32_bf16 v[112:115], v[108:111], v[28:31], v[112:115]
    v_mfma_f32_4x4x4_16b_bf16 v[124:127], v[16:17], v[16:17], v[124:127]
    v_mfma_f32_4x4x4_16b_bf16 v[128:131], v[18:19], v[18:19], v[128:131]
    v_mfma_f32_4x4x4_16b_bf16 v[132:135], v[20:21], v[20:21], v[132:135]
    v_mfma_f32_4x4x4_16b_bf16 v[136:139], v[22:23], v[22:23], v[136:139]
    v_mfma_f32_4x4x4_16b_bf16 v[124:127], v[24:25], v[24:25], v[124:127]
    v_mfma_f32_4x4x4_16b_bf16 v[128:131], v[26:27], v[26:27], v[128:131]
    v_mfma_f32_4x4x4_16b_bf16 v[132:135], v[28:29], v[28:29], v[132:135]
    v_mfma_f32_4x4x4_16b_bf16 v[136:139], v[30:31], v[30:31], v[136:139]
    v_mfma_f32_16x16x32_bf16 v[64:67], v[32:35], v[16:19], v[64:67]
    v_add_f32 v160, v163, v112
    v_mul_f32 v160, 0x3b000000, v160
    v_mfma_f32_16x16x32_bf16 v[80:83], v[32:35], v[20:23], v[80:83]
    v_add_f32 v124, v124, v128
    v_add_f32 v125, v125, v129
    v_mfma_f32_16x16x32_bf16 v[64:67], v[48:51], v[24:27], v[64:67]
    v_add_f32 v126, v126, v130
    v_add_f32 v127, v127, v131
    v_mfma_f32_16x16x32_bf16 v[80:83], v[48:51], v[28:31], v[80:83]
    v_add_f32 v132, v132, v136
    v_add_f32 v133, v133, v137
    v_mfma_f32_16x16x32_bf16 v[68:71], v[36:39], v[16:19], v[68:71]
    v_add_f32 v134, v134, v138
    v_add_f32 v135, v135, v139
    v_mfma_f32_16x16x32_bf16 v[84:87], v[36:39], v[20:23], v[84:87]
    v_cndmask_b32 v124, v124, v125, s[52:53]
    v_cndmask_b32 v126, v126, v127, s[52:53]
    v_mfma_f32_16x16x32_bf16 v[68:71], v[52:55], v[24:27], v[68:71]
    v_cndmask_b32 v132, v132, v133, s[52:53]
    v_cndmask_b32 v134, v134, v135, s[52:53]
    v_mfma_f32_16x16x32_bf16 v[84:87], v[52:55], v[28:31], v[84:87]
    v_cndmask_b32 v124, v124, v126, s[54:55]
    v_cndmask_b32 v132, v132, v134, s[54:55]
    v_mfma_f32_16x16x32_bf16 v[72:75], v[40:43], v[16:19], v[72:75]
    v_cvt_pk_bf16_f32 v96, -v160, -v160
    v_cvt_pk_bf16_f32 v98, -v160, -v160
    v_mfma_f32_16x16x32_bf16 v[88:91], v[40:43], v[20:23], v[88:91]
    v_permlane16_swap_b32 v124, v132
    v_add_f32 v124, v124, v132
    s_waitcnt lgkmcnt(6)
    v_mfma_f32_16x16x32_bf16 v[72:75], v[56:59], v[24:27], v[72:75]
    v_mov_b32 v161, v124
    v_permlane16_swap_b32 v96, v98
    v_mfma_f32_16x16x32_bf16 v[88:91], v[56:59], v[28:31], v[88:91]
    v_cvt_pk_bf16_f32 v149, 0, v160
    v_permlane32_swap_b32 v161, v124
    v_mfma_f32_16x16x32_bf16 v[76:79], v[44:47], v[16:19], v[76:79]
    v_add_f32 v161, v161, v124
    v_mul_f32 v161, 0x3b000000, v161
    v_mfma_f32_16x16x32_bf16 v[92:95], v[44:47], v[20:23], v[92:95]
    v_fma_f32 v161, -v160, v160, v161
    v_max_f32 v161, 0, v161
    s_waitcnt lgkmcnt(4)
    v_mfma_f32_16x16x32_bf16 v[76:79], v[60:63], v[24:27], v[76:79]
    v_cndmask_b32_e64 v96, 0, v96, vcc
    v_cndmask_b32_e64 v98, 0, v98, vcc
    v_mfma_f32_16x16x32_bf16 v[92:95], v[60:63], v[28:31], v[92:95]
    v_mov_b32 v97, v96
    v_mov_b32 v99, v98
    v_cvt_pk_bf16_f32 v161, 0, v161
    v_add_f32 v161, 0x3727c5ac, v161
    s_waitcnt lgkmcnt(0)
    v_mfma_f32_16x16x16_bf16 v[64:67], v[116:117], v[96:97], v[64:67]
    v_cvt_pk_bf16_f32 v161, 0, v161
    v_sqrt_f32 v161, v161
    v_mfma_f32_16x16x16_bf16 v[80:83], v[116:117], v[98:99], v[80:83]
    v_cvt_pk_bf16_f32 v161, 0, v161
    v_rcp_f32 v150, v161
    v_mfma_f32_16x16x16_bf16 v[68:71], v[118:119], v[96:97], v[68:71]
    v_mov_b32 v140, v150
    v_mov_b32 v142, v150
    s_nop 0
    v_mfma_f32_16x16x16_bf16 v[84:87], v[118:119], v[98:99], v[84:87]
    v_permlane16_swap_b32 v140, v142
    v_mul_f32 v64, v140, v64
    v_mfma_f32_16x16x16_bf16 v[72:75], v[120:121], v[96:97], v[72:75]
    v_mul_f32 v65, v140, v65
    v_mul_f32 v66, v140, v66
    v_mul_f32 v67, v140, v67
    v_mfma_f32_16x16x16_bf16 v[88:91], v[120:121], v[98:99], v[88:91]
    v_mul_f32 v80, v142, v80
    v_mul_f32 v81, v142, v81
    v_mul_f32 v82, v142, v82
    v_mfma_f32_16x16x16_bf16 v[76:79], v[122:123], v[96:97], v[76:79]
    v_mul_f32 v83, v142, v83
    v_mul_f32 v68, v140, v68
    v_mul_f32 v69, v140, v69
    v_mfma_f32_16x16x16_bf16 v[92:95], v[122:123], v[98:99], v[92:95]
    v_mul_f32 v70, v140, v70
    v_mul_f32 v71, v140, v71
    v_mul_f32 v84, v142, v84
    v_mul_f32 v85, v142, v85
    v_mul_f32 v86, v142, v86
    v_mul_f32 v87, v142, v87
    v_cvt_pk_bf16_f32 v0, v64, v65
    v_cvt_pk_bf16_f32 v2, v80, v81
    v_cvt_pk_bf16_f32 v1, v66, v67
    v_cvt_pk_bf16_f32 v3, v82, v83
    v_cvt_pk_bf16_f32 v4, v68, v69
    v_cvt_pk_bf16_f32 v6, v84, v85
    v_cvt_pk_bf16_f32 v5, v70, v71
    v_cvt_pk_bf16_f32 v7, v86, v87
    v_permlane16_swap_b32 v0, v2
    v_permlane16_swap_b32 v1, v3
    buffer_store_dwordx4 v[0:3], v167, s[40:43], s50 offen sc1
    v_pk_mul_f32 v[72:73], v[72:73], v[140:141] op_sel_hi:[1,0]
    v_pk_mul_f32 v[74:75], v[74:75], v[140:141] op_sel_hi:[1,0]
    v_pk_mul_f32 v[88:89], v[88:89], v[142:143] op_sel_hi:[1,0]
    v_pk_mul_f32 v[90:91], v[90:91], v[142:143] op_sel_hi:[1,0]
    v_permlane16_swap_b32 v4, v6
    v_permlane16_swap_b32 v5, v7
    buffer_store_dwordx4 v[4:7], v167, s[40:43], s51 offen sc1
    v_cvt_pk_bf16_f32 v8, v72, v73
    v_cvt_pk_bf16_f32 v10, v88, v89
    v_cvt_pk_bf16_f32 v9, v74, v75
    v_cvt_pk_bf16_f32 v11, v90, v91
    v_pk_mul_f32 v[76:77], v[76:77], v[140:141] op_sel_hi:[1,0]
    v_pk_mul_f32 v[78:79], v[78:79], v[140:141] op_sel_hi:[1,0]
    v_pk_mul_f32 v[92:93], v[92:93], v[142:143] op_sel_hi:[1,0]
    v_pk_mul_f32 v[94:95], v[94:95], v[142:143] op_sel_hi:[1,0]
    v_permlane16_swap_b32 v8, v10
    v_permlane16_swap_b32 v9, v11
    buffer_store_dwordx4 v[8:11], v167, s[40:43], s57 offen sc1
    v_cvt_pk_bf16_f32 v12, v76, v77
    v_cvt_pk_bf16_f32 v14, v92, v93
    v_cvt_pk_bf16_f32 v13, v78, v79
    v_cvt_pk_bf16_f32 v15, v94, v95
    v_permlane16_swap_b32 v12, v14
    s_nop 0
    v_permlane16_swap_b32 v13, v15
    buffer_store_dwordx4 v[12:15], v167, s[40:43], s59 offen sc1
    s_setprio 1
    s_barrier
    s_branch L_a_join
.fill ((2800 - (. - recurrent_scan__softmax_full_mha__moe_arch_mod__prompt_kernel)) & 0xfff) >> 2, 4, 0xbf800000
L_a_v:
    s_barrier
    ds_read_b128 v[12:15], v5
    ds_read_b64_tr_b16 v[32:33], v148 offset:0
    ds_read_b64_tr_b16 v[34:35], v148 offset:512
    ds_read_b64_tr_b16 v[36:37], v149 offset:0
    ds_read_b64_tr_b16 v[38:39], v149 offset:512
    ds_read_b64_tr_b16 v[40:41], v150 offset:0
    ds_read_b64_tr_b16 v[42:43], v150 offset:512
    ds_read_b64_tr_b16 v[44:45], v151 offset:0
    ds_read_b64_tr_b16 v[46:47], v151 offset:512
    s_waitcnt lgkmcnt(8)
    v_mfma_f32_16x16x32_bf16 v[16:19], v[8:11], v[12:15], 0
    s_nop 7
    v_add_f32_dpp v16, v16, v16 row_ror:8 row_mask:0xf bank_mask:0xf
    s_nop 1
    v_add_f32_dpp v16, v16, v16 row_ror:4 row_mask:0xf bank_mask:0xf
    s_nop 1
    v_add_f32_dpp v16, v16, v16 row_ror:2 row_mask:0xf bank_mask:0xf
    s_nop 1
    v_add_f32_dpp v16, v16, v16 row_ror:1 row_mask:0xf bank_mask:0xf
    s_nop 0
    v_readfirstlane_b32 s70, v16
    s_mov_b64 exec, s[68:69]
    ds_read_b128 v[96:99], v153 offset:0
    ds_read_b128 v[104:107], v153 offset:64
    s_mov_b64 exec, s[78:79]
    ds_read_b128 v[100:103], v153 offset:0
    ds_read_b128 v[108:111], v153 offset:64
    s_mov_b64 exec, -1
    s_waitcnt lgkmcnt(0)
    s_barrier
    ds_read_b128 v[0:3], v144 offset:0
    ds_read_b128 v[4:7], v144 offset:2048
    s_waitcnt lgkmcnt(1)
    v_mfma_f32_16x16x32_bf16 v[64:67], v[0:3], v[32:35], 0
    ds_read_b128 v[8:11], v145 offset:0
    ds_read_b128 v[12:15], v145 offset:2048
    s_waitcnt lgkmcnt(2)
    v_mfma_f32_16x16x32_bf16 v[80:83], v[4:7], v[32:35], 0
    ds_read_b64_tr_b16 v[48:49], v148 offset:4096
    ds_read_b64_tr_b16 v[50:51], v148 offset:4608
    v_mfma_f32_16x16x32_bf16 v[140:143], v[96:99], v[32:35], 0
    ds_read_b64_tr_b16 v[52:53], v149 offset:4096
    ds_read_b64_tr_b16 v[54:55], v149 offset:4608
    v_mfma_f32_16x16x32_bf16 v[68:71], v[0:3], v[36:39], 0
    ds_read_b64_tr_b16 v[56:57], v150 offset:4096
    ds_read_b64_tr_b16 v[58:59], v150 offset:4608
    v_mfma_f32_16x16x32_bf16 v[84:87], v[4:7], v[36:39], 0
    ds_read_b64_tr_b16 v[60:61], v151 offset:4096
    ds_read_b64_tr_b16 v[62:63], v151 offset:4608
    v_mfma_f32_16x16x32_bf16 v[72:75], v[0:3], v[40:43], 0
    ds_read_b64_tr_b16 v[32:33], v148 offset:8192
    ds_read_b64_tr_b16 v[34:35], v148 offset:8704
    v_mfma_f32_16x16x32_bf16 v[88:91], v[4:7], v[40:43], 0
    ds_read_b64_tr_b16 v[36:37], v149 offset:8192
    ds_read_b64_tr_b16 v[38:39], v149 offset:8704
    v_mfma_f32_16x16x32_bf16 v[76:79], v[0:3], v[44:47], 0
    ds_read_b64_tr_b16 v[40:41], v150 offset:8192
    s_waitcnt lgkmcnt(9)
    ds_read_b64_tr_b16 v[42:43], v150 offset:8704
    v_mfma_f32_16x16x32_bf16 v[92:95], v[4:7], v[44:47], 0
    v_mfma_f32_16x16x32_bf16 v[116:119], v[96:99], v[0:3], 0
    ds_read_b64_tr_b16 v[44:45], v151 offset:8192
    ds_read_b64_tr_b16 v[46:47], v151 offset:8704
    v_mfma_f32_16x16x32_bf16 v[116:119], v[100:103], v[4:7], v[116:119]
    v_mfma_f32_16x16x32_bf16 v[116:119], v[104:107], v[8:11], v[116:119]
    v_mfma_f32_16x16x32_bf16 v[116:119], v[108:111], v[12:15], v[116:119]
    v_mfma_f32_4x4x4_16b_bf16 v[124:127], v[0:1], v[0:1], 0
    v_mfma_f32_4x4x4_16b_bf16 v[128:131], v[2:3], v[2:3], 0
    v_mfma_f32_4x4x4_16b_bf16 v[132:135], v[4:5], v[4:5], 0
    v_mfma_f32_4x4x4_16b_bf16 v[136:139], v[6:7], v[6:7], 0
    v_mfma_f32_4x4x4_16b_bf16 v[124:127], v[8:9], v[8:9], v[124:127]
    v_mfma_f32_4x4x4_16b_bf16 v[128:131], v[10:11], v[10:11], v[128:131]
    v_mfma_f32_4x4x4_16b_bf16 v[132:135], v[12:13], v[12:13], v[132:135]
    v_mfma_f32_4x4x4_16b_bf16 v[136:139], v[14:15], v[14:15], v[136:139]
    s_barrier
    ds_read_b128 v[16:19], v144 offset:16384
    ds_read_b128 v[20:23], v144 offset:18432
    v_mfma_f32_16x16x32_bf16 v[64:67], v[8:11], v[48:51], v[64:67]
    ds_read_b128 v[24:27], v145 offset:16384
    s_waitcnt lgkmcnt(9)
    ds_read_b128 v[28:31], v145 offset:18432
    v_mfma_f32_16x16x32_bf16 v[80:83], v[12:15], v[48:51], v[80:83]
    v_mfma_f32_16x16x32_bf16 v[140:143], v[96:99], v[48:51], v[140:143]
    v_mfma_f32_16x16x32_bf16 v[68:71], v[8:11], v[52:55], v[68:71]
    ds_read_b64_tr_b16 v[48:49], v148 offset:12288
    ds_read_b64_tr_b16 v[50:51], v148 offset:12800
    v_mfma_f32_16x16x32_bf16 v[84:87], v[12:15], v[52:55], v[84:87]
    v_mfma_f32_16x16x32_bf16 v[72:75], v[8:11], v[56:59], v[72:75]
    ds_read_b64_tr_b16 v[52:53], v149 offset:12288
    ds_read_b64_tr_b16 v[54:55], v149 offset:12800
    v_mfma_f32_16x16x32_bf16 v[88:91], v[12:15], v[56:59], v[88:91]
    v_mfma_f32_16x16x32_bf16 v[76:79], v[8:11], v[60:63], v[76:79]
    ds_read_b64_tr_b16 v[56:57], v150 offset:12288
    s_waitcnt lgkmcnt(9)
    ds_read_b64_tr_b16 v[58:59], v150 offset:12800
    v_mfma_f32_16x16x32_bf16 v[92:95], v[12:15], v[60:63], v[92:95]
    s_waitcnt lgkmcnt(9)
    v_mfma_f32_16x16x32_bf16 v[64:67], v[16:19], v[32:35], v[64:67]
    ds_read_b64_tr_b16 v[60:61], v151 offset:12288
    ds_read_b64_tr_b16 v[62:63], v151 offset:12800
    s_waitcnt lgkmcnt(10)
    v_mfma_f32_16x16x32_bf16 v[80:83], v[20:23], v[32:35], v[80:83]
    v_mfma_f32_16x16x32_bf16 v[140:143], v[96:99], v[32:35], v[140:143]
    v_mfma_f32_16x16x32_bf16 v[68:71], v[16:19], v[36:39], v[68:71]
    ds_read_b64_tr_b16 v[32:33], v148 offset:16384
    ds_read_b64_tr_b16 v[34:35], v148 offset:16896
    v_mfma_f32_16x16x32_bf16 v[84:87], v[20:23], v[36:39], v[84:87]
    v_mfma_f32_16x16x32_bf16 v[72:75], v[16:19], v[40:43], v[72:75]
    ds_read_b64_tr_b16 v[36:37], v149 offset:16384
    ds_read_b64_tr_b16 v[38:39], v149 offset:16896
    v_mfma_f32_16x16x32_bf16 v[88:91], v[20:23], v[40:43], v[88:91]
    v_mfma_f32_16x16x32_bf16 v[76:79], v[16:19], v[44:47], v[76:79]
    ds_read_b64_tr_b16 v[40:41], v150 offset:16384
    s_waitcnt lgkmcnt(9)
    ds_read_b64_tr_b16 v[42:43], v150 offset:16896
    v_mfma_f32_16x16x32_bf16 v[92:95], v[20:23], v[44:47], v[92:95]
    v_mfma_f32_16x16x32_bf16 v[112:115], v[96:99], v[16:19], 0
    ds_read_b64_tr_b16 v[44:45], v151 offset:16384
    ds_read_b64_tr_b16 v[46:47], v151 offset:16896
    v_mfma_f32_16x16x32_bf16 v[112:115], v[100:103], v[20:23], v[112:115]
    v_mfma_f32_16x16x32_bf16 v[112:115], v[104:107], v[24:27], v[112:115]
    v_mfma_f32_16x16x32_bf16 v[112:115], v[108:111], v[28:31], v[112:115]
    v_mfma_f32_4x4x4_16b_bf16 v[124:127], v[16:17], v[16:17], v[124:127]
    v_mfma_f32_4x4x4_16b_bf16 v[128:131], v[18:19], v[18:19], v[128:131]
    v_mfma_f32_4x4x4_16b_bf16 v[132:135], v[20:21], v[20:21], v[132:135]
    v_mfma_f32_4x4x4_16b_bf16 v[136:139], v[22:23], v[22:23], v[136:139]
    v_mfma_f32_4x4x4_16b_bf16 v[124:127], v[24:25], v[24:25], v[124:127]
    v_mfma_f32_4x4x4_16b_bf16 v[128:131], v[26:27], v[26:27], v[128:131]
    v_mfma_f32_4x4x4_16b_bf16 v[132:135], v[28:29], v[28:29], v[132:135]
    v_mfma_f32_4x4x4_16b_bf16 v[136:139], v[30:31], v[30:31], v[136:139]
    s_barrier
    ds_read_b128 v[0:3], v144 offset:32768
    ds_read_b128 v[4:7], v144 offset:34816
    v_mfma_f32_16x16x32_bf16 v[64:67], v[24:27], v[48:51], v[64:67]
    ds_read_b128 v[8:11], v145 offset:32768
    s_waitcnt lgkmcnt(9)
    ds_read_b128 v[12:15], v145 offset:34816
    v_mfma_f32_16x16x32_bf16 v[80:83], v[28:31], v[48:51], v[80:83]
    v_mfma_f32_16x16x32_bf16 v[140:143], v[96:99], v[48:51], v[140:143]
    v_mfma_f32_16x16x32_bf16 v[68:71], v[24:27], v[52:55], v[68:71]
    ds_read_b64_tr_b16 v[48:49], v148 offset:20480
    ds_read_b64_tr_b16 v[50:51], v148 offset:20992
    v_mfma_f32_16x16x32_bf16 v[84:87], v[28:31], v[52:55], v[84:87]
    v_mfma_f32_16x16x32_bf16 v[72:75], v[24:27], v[56:59], v[72:75]
    ds_read_b64_tr_b16 v[52:53], v149 offset:20480
    ds_read_b64_tr_b16 v[54:55], v149 offset:20992
    v_mfma_f32_16x16x32_bf16 v[88:91], v[28:31], v[56:59], v[88:91]
    v_mfma_f32_16x16x32_bf16 v[76:79], v[24:27], v[60:63], v[76:79]
    ds_read_b64_tr_b16 v[56:57], v150 offset:20480
    s_waitcnt lgkmcnt(9)
    ds_read_b64_tr_b16 v[58:59], v150 offset:20992
    v_mfma_f32_16x16x32_bf16 v[92:95], v[28:31], v[60:63], v[92:95]
    s_waitcnt lgkmcnt(9)
    v_mfma_f32_16x16x32_bf16 v[64:67], v[0:3], v[32:35], v[64:67]
    ds_read_b64_tr_b16 v[60:61], v151 offset:20480
    ds_read_b64_tr_b16 v[62:63], v151 offset:20992
    s_waitcnt lgkmcnt(10)
    v_mfma_f32_16x16x32_bf16 v[80:83], v[4:7], v[32:35], v[80:83]
    v_mfma_f32_16x16x32_bf16 v[140:143], v[96:99], v[32:35], v[140:143]
    v_mfma_f32_16x16x32_bf16 v[68:71], v[0:3], v[36:39], v[68:71]
    ds_read_b64_tr_b16 v[32:33], v148 offset:24576
    ds_read_b64_tr_b16 v[34:35], v148 offset:25088
    v_mfma_f32_16x16x32_bf16 v[84:87], v[4:7], v[36:39], v[84:87]
    v_mfma_f32_16x16x32_bf16 v[72:75], v[0:3], v[40:43], v[72:75]
    ds_read_b64_tr_b16 v[36:37], v149 offset:24576
    ds_read_b64_tr_b16 v[38:39], v149 offset:25088
    v_mfma_f32_16x16x32_bf16 v[88:91], v[4:7], v[40:43], v[88:91]
    v_mfma_f32_16x16x32_bf16 v[76:79], v[0:3], v[44:47], v[76:79]
    ds_read_b64_tr_b16 v[40:41], v150 offset:24576
    s_waitcnt lgkmcnt(9)
    ds_read_b64_tr_b16 v[42:43], v150 offset:25088
    v_mfma_f32_16x16x32_bf16 v[92:95], v[4:7], v[44:47], v[92:95]
    v_mfma_f32_16x16x32_bf16 v[120:123], v[96:99], v[0:3], 0
    ds_read_b64_tr_b16 v[44:45], v151 offset:24576
    ds_read_b64_tr_b16 v[46:47], v151 offset:25088
    v_mfma_f32_16x16x32_bf16 v[120:123], v[100:103], v[4:7], v[120:123]
    v_mfma_f32_16x16x32_bf16 v[120:123], v[104:107], v[8:11], v[120:123]
    v_mfma_f32_16x16x32_bf16 v[120:123], v[108:111], v[12:15], v[120:123]
    v_mfma_f32_4x4x4_16b_bf16 v[124:127], v[0:1], v[0:1], v[124:127]
    v_mfma_f32_4x4x4_16b_bf16 v[128:131], v[2:3], v[2:3], v[128:131]
    v_mfma_f32_4x4x4_16b_bf16 v[132:135], v[4:5], v[4:5], v[132:135]
    v_mfma_f32_4x4x4_16b_bf16 v[136:139], v[6:7], v[6:7], v[136:139]
    v_mfma_f32_4x4x4_16b_bf16 v[124:127], v[8:9], v[8:9], v[124:127]
    v_mfma_f32_4x4x4_16b_bf16 v[128:131], v[10:11], v[10:11], v[128:131]
    v_mfma_f32_4x4x4_16b_bf16 v[132:135], v[12:13], v[12:13], v[132:135]
    v_mfma_f32_4x4x4_16b_bf16 v[136:139], v[14:15], v[14:15], v[136:139]
    s_mov_b64 exec, s[68:69]
    ds_read_b128 v[96:99], v153 offset:384
    ds_read_b128 v[104:107], v153 offset:448
    s_mov_b64 exec, s[78:79]
    ds_read_b128 v[100:103], v153 offset:384
    s_waitcnt lgkmcnt(9)
    ds_read_b128 v[108:111], v153 offset:448
    s_mov_b64 exec, -1
    s_barrier
    ds_read_b128 v[16:19], v144 offset:49152
    ds_read_b128 v[20:23], v144 offset:51200
    v_mfma_f32_16x16x32_bf16 v[64:67], v[8:11], v[48:51], v[64:67]
    ds_read_b128 v[24:27], v145 offset:49152
    ds_read_b128 v[28:31], v145 offset:51200
    v_mfma_f32_16x16x32_bf16 v[80:83], v[12:15], v[48:51], v[80:83]
    v_mfma_f32_16x16x32_bf16 v[140:143], v[96:99], v[48:51], v[140:143]
    v_mfma_f32_16x16x32_bf16 v[68:71], v[8:11], v[52:55], v[68:71]
    ds_read_b64_tr_b16 v[48:49], v148 offset:28672
    s_waitcnt lgkmcnt(9)
    ds_read_b64_tr_b16 v[50:51], v148 offset:29184
    v_mfma_f32_16x16x32_bf16 v[84:87], v[12:15], v[52:55], v[84:87]
    v_mfma_f32_16x16x32_bf16 v[72:75], v[8:11], v[56:59], v[72:75]
    ds_read_b64_tr_b16 v[52:53], v149 offset:28672
    ds_read_b64_tr_b16 v[54:55], v149 offset:29184
    v_mfma_f32_16x16x32_bf16 v[88:91], v[12:15], v[56:59], v[88:91]
    v_mfma_f32_16x16x32_bf16 v[76:79], v[8:11], v[60:63], v[76:79]
    ds_read_b64_tr_b16 v[56:57], v150 offset:28672
    ds_read_b64_tr_b16 v[58:59], v150 offset:29184
    v_mfma_f32_16x16x32_bf16 v[92:95], v[12:15], v[60:63], v[92:95]
    s_waitcnt lgkmcnt(9)
    v_mfma_f32_16x16x32_bf16 v[64:67], v[16:19], v[32:35], v[64:67]
    ds_read_b64_tr_b16 v[60:61], v151 offset:28672
    ds_read_b64_tr_b16 v[62:63], v151 offset:29184
    s_waitcnt lgkmcnt(10)
    v_mfma_f32_16x16x32_bf16 v[80:83], v[20:23], v[32:35], v[80:83]
    v_mfma_f32_16x16x32_bf16 v[140:143], v[96:99], v[32:35], v[140:143]
    v_mfma_f32_16x16x32_bf16 v[68:71], v[16:19], v[36:39], v[68:71]
    ds_read_b64_tr_b16 v[32:33], v148 offset:32768
    ds_read_b64_tr_b16 v[34:35], v148 offset:33280
    v_mfma_f32_16x16x32_bf16 v[84:87], v[20:23], v[36:39], v[84:87]
    v_mfma_f32_16x16x32_bf16 v[72:75], v[16:19], v[40:43], v[72:75]
    ds_read_b64_tr_b16 v[36:37], v149 offset:32768
    ds_read_b64_tr_b16 v[38:39], v149 offset:33280
    v_mfma_f32_16x16x32_bf16 v[88:91], v[20:23], v[40:43], v[88:91]
    v_mfma_f32_16x16x32_bf16 v[76:79], v[16:19], v[44:47], v[76:79]
    ds_read_b64_tr_b16 v[40:41], v150 offset:32768
    s_waitcnt lgkmcnt(9)
    ds_read_b64_tr_b16 v[42:43], v150 offset:33280
    v_mfma_f32_16x16x32_bf16 v[92:95], v[20:23], v[44:47], v[92:95]
    v_mfma_f32_16x16x32_bf16 v[116:119], v[96:99], v[16:19], v[116:119]
    ds_read_b64_tr_b16 v[44:45], v151 offset:32768
    ds_read_b64_tr_b16 v[46:47], v151 offset:33280
    v_mfma_f32_16x16x32_bf16 v[116:119], v[100:103], v[20:23], v[116:119]
    v_mfma_f32_16x16x32_bf16 v[116:119], v[104:107], v[24:27], v[116:119]
    v_mfma_f32_16x16x32_bf16 v[116:119], v[108:111], v[28:31], v[116:119]
    v_mfma_f32_4x4x4_16b_bf16 v[124:127], v[16:17], v[16:17], v[124:127]
    v_mfma_f32_4x4x4_16b_bf16 v[128:131], v[18:19], v[18:19], v[128:131]
    v_mfma_f32_4x4x4_16b_bf16 v[132:135], v[20:21], v[20:21], v[132:135]
    v_mfma_f32_4x4x4_16b_bf16 v[136:139], v[22:23], v[22:23], v[136:139]
    v_mfma_f32_4x4x4_16b_bf16 v[124:127], v[24:25], v[24:25], v[124:127]
    v_mfma_f32_4x4x4_16b_bf16 v[128:131], v[26:27], v[26:27], v[128:131]
    v_mfma_f32_4x4x4_16b_bf16 v[132:135], v[28:29], v[28:29], v[132:135]
    v_mfma_f32_4x4x4_16b_bf16 v[136:139], v[30:31], v[30:31], v[136:139]
    s_barrier
    ds_read_b128 v[0:3], v146 offset:0
    ds_read_b128 v[4:7], v146 offset:2048
    v_mfma_f32_16x16x32_bf16 v[64:67], v[24:27], v[48:51], v[64:67]
    ds_read_b128 v[8:11], v147 offset:0
    s_waitcnt lgkmcnt(9)
    ds_read_b128 v[12:15], v147 offset:2048
    v_mfma_f32_16x16x32_bf16 v[80:83], v[28:31], v[48:51], v[80:83]
    v_mfma_f32_16x16x32_bf16 v[140:143], v[96:99], v[48:51], v[140:143]
    v_mfma_f32_16x16x32_bf16 v[68:71], v[24:27], v[52:55], v[68:71]
    ds_read_b64_tr_b16 v[48:49], v148 offset:36864
    ds_read_b64_tr_b16 v[50:51], v148 offset:37376
    v_mfma_f32_16x16x32_bf16 v[84:87], v[28:31], v[52:55], v[84:87]
    v_mfma_f32_16x16x32_bf16 v[72:75], v[24:27], v[56:59], v[72:75]
    ds_read_b64_tr_b16 v[52:53], v149 offset:36864
    ds_read_b64_tr_b16 v[54:55], v149 offset:37376
    v_mfma_f32_16x16x32_bf16 v[88:91], v[28:31], v[56:59], v[88:91]
    v_mfma_f32_16x16x32_bf16 v[76:79], v[24:27], v[60:63], v[76:79]
    ds_read_b64_tr_b16 v[56:57], v150 offset:36864
    s_waitcnt lgkmcnt(9)
    ds_read_b64_tr_b16 v[58:59], v150 offset:37376
    v_mfma_f32_16x16x32_bf16 v[92:95], v[28:31], v[60:63], v[92:95]
    s_waitcnt lgkmcnt(9)
    v_mfma_f32_16x16x32_bf16 v[64:67], v[0:3], v[32:35], v[64:67]
    ds_read_b64_tr_b16 v[60:61], v151 offset:36864
    ds_read_b64_tr_b16 v[62:63], v151 offset:37376
    s_waitcnt lgkmcnt(10)
    v_mfma_f32_16x16x32_bf16 v[80:83], v[4:7], v[32:35], v[80:83]
    v_mfma_f32_16x16x32_bf16 v[140:143], v[96:99], v[32:35], v[140:143]
    v_mfma_f32_16x16x32_bf16 v[68:71], v[0:3], v[36:39], v[68:71]
    ds_read_b64_tr_b16 v[32:33], v148 offset:40960
    ds_read_b64_tr_b16 v[34:35], v148 offset:41472
    v_mfma_f32_16x16x32_bf16 v[84:87], v[4:7], v[36:39], v[84:87]
    v_mfma_f32_16x16x32_bf16 v[72:75], v[0:3], v[40:43], v[72:75]
    ds_read_b64_tr_b16 v[36:37], v149 offset:40960
    ds_read_b64_tr_b16 v[38:39], v149 offset:41472
    v_mfma_f32_16x16x32_bf16 v[88:91], v[4:7], v[40:43], v[88:91]
    v_mfma_f32_16x16x32_bf16 v[76:79], v[0:3], v[44:47], v[76:79]
    ds_read_b64_tr_b16 v[40:41], v150 offset:40960
    s_waitcnt lgkmcnt(9)
    ds_read_b64_tr_b16 v[42:43], v150 offset:41472
    v_mfma_f32_16x16x32_bf16 v[92:95], v[4:7], v[44:47], v[92:95]
    v_mfma_f32_16x16x32_bf16 v[112:115], v[96:99], v[0:3], v[112:115]
    ds_read_b64_tr_b16 v[44:45], v151 offset:40960
    ds_read_b64_tr_b16 v[46:47], v151 offset:41472
    v_mfma_f32_16x16x32_bf16 v[112:115], v[100:103], v[4:7], v[112:115]
    v_mfma_f32_16x16x32_bf16 v[112:115], v[104:107], v[8:11], v[112:115]
    v_mfma_f32_16x16x32_bf16 v[112:115], v[108:111], v[12:15], v[112:115]
    v_mfma_f32_4x4x4_16b_bf16 v[124:127], v[0:1], v[0:1], v[124:127]
    v_mfma_f32_4x4x4_16b_bf16 v[128:131], v[2:3], v[2:3], v[128:131]
    v_mfma_f32_4x4x4_16b_bf16 v[132:135], v[4:5], v[4:5], v[132:135]
    v_mfma_f32_4x4x4_16b_bf16 v[136:139], v[6:7], v[6:7], v[136:139]
    v_mfma_f32_4x4x4_16b_bf16 v[124:127], v[8:9], v[8:9], v[124:127]
    v_mfma_f32_4x4x4_16b_bf16 v[128:131], v[10:11], v[10:11], v[128:131]
    v_mfma_f32_4x4x4_16b_bf16 v[132:135], v[12:13], v[12:13], v[132:135]
    v_mfma_f32_4x4x4_16b_bf16 v[136:139], v[14:15], v[14:15], v[136:139]
    s_barrier
    ds_read_b128 v[16:19], v144 offset:0
    ds_read_b128 v[20:23], v144 offset:2048
    v_mfma_f32_16x16x32_bf16 v[64:67], v[8:11], v[48:51], v[64:67]
    ds_read_b128 v[24:27], v145 offset:0
    s_waitcnt lgkmcnt(9)
    ds_read_b128 v[28:31], v145 offset:2048
    v_mfma_f32_16x16x32_bf16 v[80:83], v[12:15], v[48:51], v[80:83]
    v_mfma_f32_16x16x32_bf16 v[140:143], v[96:99], v[48:51], v[140:143]
    v_mfma_f32_16x16x32_bf16 v[68:71], v[8:11], v[52:55], v[68:71]
    ds_read_b64_tr_b16 v[48:49], v148 offset:45056
    ds_read_b64_tr_b16 v[50:51], v148 offset:45568
    v_mfma_f32_16x16x32_bf16 v[84:87], v[12:15], v[52:55], v[84:87]
    v_mfma_f32_16x16x32_bf16 v[72:75], v[8:11], v[56:59], v[72:75]
    ds_read_b64_tr_b16 v[52:53], v149 offset:45056
    ds_read_b64_tr_b16 v[54:55], v149 offset:45568
    v_mfma_f32_16x16x32_bf16 v[88:91], v[12:15], v[56:59], v[88:91]
    v_mfma_f32_16x16x32_bf16 v[76:79], v[8:11], v[60:63], v[76:79]
    ds_read_b64_tr_b16 v[56:57], v150 offset:45056
    s_waitcnt lgkmcnt(9)
    ds_read_b64_tr_b16 v[58:59], v150 offset:45568
    v_mfma_f32_16x16x32_bf16 v[92:95], v[12:15], v[60:63], v[92:95]
    s_waitcnt lgkmcnt(9)
    v_mfma_f32_16x16x32_bf16 v[64:67], v[16:19], v[32:35], v[64:67]
    ds_read_b64_tr_b16 v[60:61], v151 offset:45056
    ds_read_b64_tr_b16 v[62:63], v151 offset:45568
    s_waitcnt lgkmcnt(10)
    v_mfma_f32_16x16x32_bf16 v[80:83], v[20:23], v[32:35], v[80:83]
    v_mfma_f32_16x16x32_bf16 v[140:143], v[96:99], v[32:35], v[140:143]
    v_mfma_f32_16x16x32_bf16 v[68:71], v[16:19], v[36:39], v[68:71]
    ds_read_b64_tr_b16 v[32:33], v148 offset:49152
    ds_read_b64_tr_b16 v[34:35], v148 offset:49664
    v_mfma_f32_16x16x32_bf16 v[84:87], v[20:23], v[36:39], v[84:87]
    v_mfma_f32_16x16x32_bf16 v[72:75], v[16:19], v[40:43], v[72:75]
    ds_read_b64_tr_b16 v[36:37], v149 offset:49152
    ds_read_b64_tr_b16 v[38:39], v149 offset:49664
    v_mfma_f32_16x16x32_bf16 v[88:91], v[20:23], v[40:43], v[88:91]
    v_mfma_f32_16x16x32_bf16 v[76:79], v[16:19], v[44:47], v[76:79]
    ds_read_b64_tr_b16 v[40:41], v150 offset:49152
    s_waitcnt lgkmcnt(9)
    ds_read_b64_tr_b16 v[42:43], v150 offset:49664
    v_mfma_f32_16x16x32_bf16 v[92:95], v[20:23], v[44:47], v[92:95]
    v_mfma_f32_16x16x32_bf16 v[120:123], v[96:99], v[16:19], v[120:123]
    ds_read_b64_tr_b16 v[44:45], v151 offset:49152
    ds_read_b64_tr_b16 v[46:47], v151 offset:49664
    v_mfma_f32_16x16x32_bf16 v[120:123], v[100:103], v[20:23], v[120:123]
    v_mfma_f32_16x16x32_bf16 v[120:123], v[104:107], v[24:27], v[120:123]
    v_mfma_f32_16x16x32_bf16 v[120:123], v[108:111], v[28:31], v[120:123]
    v_mfma_f32_4x4x4_16b_bf16 v[124:127], v[16:17], v[16:17], v[124:127]
    v_mfma_f32_4x4x4_16b_bf16 v[128:131], v[18:19], v[18:19], v[128:131]
    v_mfma_f32_4x4x4_16b_bf16 v[132:135], v[20:21], v[20:21], v[132:135]
    v_mfma_f32_4x4x4_16b_bf16 v[136:139], v[22:23], v[22:23], v[136:139]
    v_mfma_f32_4x4x4_16b_bf16 v[124:127], v[24:25], v[24:25], v[124:127]
    v_mfma_f32_4x4x4_16b_bf16 v[128:131], v[26:27], v[26:27], v[128:131]
    v_mfma_f32_4x4x4_16b_bf16 v[132:135], v[28:29], v[28:29], v[132:135]
    v_mfma_f32_4x4x4_16b_bf16 v[136:139], v[30:31], v[30:31], v[136:139]
    s_mov_b64 exec, s[68:69]
    ds_read_b128 v[96:99], v153 offset:768
    ds_read_b128 v[104:107], v153 offset:832
    s_mov_b64 exec, s[78:79]
    ds_read_b128 v[100:103], v153 offset:768
    s_waitcnt lgkmcnt(9)
    ds_read_b128 v[108:111], v153 offset:832
    s_mov_b64 exec, -1
    s_barrier
    ds_read_b128 v[0:3], v144 offset:16384
    ds_read_b128 v[4:7], v144 offset:18432
    v_mfma_f32_16x16x32_bf16 v[64:67], v[24:27], v[48:51], v[64:67]
    ds_read_b128 v[8:11], v145 offset:16384
    ds_read_b128 v[12:15], v145 offset:18432
    v_mfma_f32_16x16x32_bf16 v[80:83], v[28:31], v[48:51], v[80:83]
    v_mfma_f32_16x16x32_bf16 v[140:143], v[96:99], v[48:51], v[140:143]
    v_mfma_f32_16x16x32_bf16 v[68:71], v[24:27], v[52:55], v[68:71]
    ds_read_b64_tr_b16 v[48:49], v148 offset:53248
    s_waitcnt lgkmcnt(9)
    ds_read_b64_tr_b16 v[50:51], v148 offset:53760
    v_mfma_f32_16x16x32_bf16 v[84:87], v[28:31], v[52:55], v[84:87]
    v_mfma_f32_16x16x32_bf16 v[72:75], v[24:27], v[56:59], v[72:75]
    ds_read_b64_tr_b16 v[52:53], v149 offset:53248
    ds_read_b64_tr_b16 v[54:55], v149 offset:53760
    v_mfma_f32_16x16x32_bf16 v[88:91], v[28:31], v[56:59], v[88:91]
    v_mfma_f32_16x16x32_bf16 v[76:79], v[24:27], v[60:63], v[76:79]
    ds_read_b64_tr_b16 v[56:57], v150 offset:53248
    ds_read_b64_tr_b16 v[58:59], v150 offset:53760
    v_mfma_f32_16x16x32_bf16 v[92:95], v[28:31], v[60:63], v[92:95]
    s_waitcnt lgkmcnt(9)
    v_mfma_f32_16x16x32_bf16 v[64:67], v[0:3], v[32:35], v[64:67]
    ds_read_b64_tr_b16 v[60:61], v151 offset:53248
    ds_read_b64_tr_b16 v[62:63], v151 offset:53760
    s_waitcnt lgkmcnt(10)
    v_mfma_f32_16x16x32_bf16 v[80:83], v[4:7], v[32:35], v[80:83]
    v_mfma_f32_16x16x32_bf16 v[140:143], v[96:99], v[32:35], v[140:143]
    s_waitcnt lgkmcnt(6)
    v_mfma_f32_16x16x32_bf16 v[64:67], v[8:11], v[48:51], v[64:67]
    ds_read_b64_tr_b16 v[32:33], v148 offset:57344
    ds_read_b64_tr_b16 v[34:35], v148 offset:57856
    v_mfma_f32_16x16x32_bf16 v[80:83], v[12:15], v[48:51], v[80:83]
    v_mfma_f32_16x16x32_bf16 v[140:143], v[96:99], v[48:51], v[140:143]
    v_mfma_f32_16x16x32_bf16 v[68:71], v[0:3], v[36:39], v[68:71]
    ds_read_b64_tr_b16 v[48:49], v148 offset:61440
    ds_read_b64_tr_b16 v[50:51], v148 offset:61952
    v_mfma_f32_16x16x32_bf16 v[84:87], v[4:7], v[36:39], v[84:87]
    v_mfma_f32_16x16x32_bf16 v[72:75], v[0:3], v[40:43], v[72:75]
    ds_read_b64_tr_b16 v[36:37], v149 offset:57344
    ds_read_b64_tr_b16 v[38:39], v149 offset:57856
    v_mfma_f32_16x16x32_bf16 v[88:91], v[4:7], v[40:43], v[88:91]
    v_mfma_f32_16x16x32_bf16 v[76:79], v[0:3], v[44:47], v[76:79]
    ds_read_b64_tr_b16 v[40:41], v150 offset:57344
    ds_read_b64_tr_b16 v[42:43], v150 offset:57856
    v_mfma_f32_16x16x32_bf16 v[92:95], v[4:7], v[44:47], v[92:95]
    s_waitcnt lgkmcnt(6)
    v_mfma_f32_16x16x32_bf16 v[140:143], v[96:99], v[32:35], v[140:143]
    ds_read_b64_tr_b16 v[44:45], v151 offset:57344
    ds_read_b64_tr_b16 v[46:47], v151 offset:57856
    s_waitcnt lgkmcnt(6)
    v_mfma_f32_16x16x32_bf16 v[140:143], v[96:99], v[48:51], v[140:143]
    v_mfma_f32_16x16x32_bf16 v[68:71], v[8:11], v[52:55], v[68:71]
    v_mfma_f32_16x16x32_bf16 v[84:87], v[12:15], v[52:55], v[84:87]
    ds_read_b64_tr_b16 v[52:53], v149 offset:61440
    ds_read_b64_tr_b16 v[54:55], v149 offset:61952
    v_mfma_f32_16x16x32_bf16 v[116:119], v[96:99], v[0:3], v[116:119]
    s_nop 1
    s_nop 0
    v_and_b32 v160, 0xffff0000, v140
    v_mfma_f32_16x16x32_bf16 v[116:119], v[100:103], v[4:7], v[116:119]
    v_sub_f32 v161, v140, v160
    v_and_b32 v162, 0xffff0000, v161
    v_mfma_f32_16x16x32_bf16 v[116:119], v[104:107], v[8:11], v[116:119]
    v_sub_f32 v161, v161, v162
    v_lshrrev_b32 v160, 16, v160
    v_mfma_f32_16x16x32_bf16 v[116:119], v[108:111], v[12:15], v[116:119]
    v_or_b32 v160, v160, v162
    v_lshrrev_b32 v161, 16, v161
    s_mov_b64 exec, s[62:63]
    ds_write_b64 v158, v[160:161]
    s_mov_b64 exec, -1
    v_mfma_f32_4x4x4_16b_bf16 v[124:127], v[0:1], v[0:1], v[124:127]
    v_mfma_f32_4x4x4_16b_bf16 v[128:131], v[2:3], v[2:3], v[128:131]
    v_mfma_f32_4x4x4_16b_bf16 v[132:135], v[4:5], v[4:5], v[132:135]
    v_mfma_f32_4x4x4_16b_bf16 v[136:139], v[6:7], v[6:7], v[136:139]
    v_mfma_f32_4x4x4_16b_bf16 v[124:127], v[8:9], v[8:9], v[124:127]
    v_mfma_f32_4x4x4_16b_bf16 v[128:131], v[10:11], v[10:11], v[128:131]
    v_add_f32 v163, v116, v120
    v_mfma_f32_4x4x4_16b_bf16 v[132:135], v[12:13], v[12:13], v[132:135]
    v_add_f32 v157, v117, v123
    v_mfma_f32_4x4x4_16b_bf16 v[136:139], v[14:15], v[14:15], v[136:139]
    s_waitcnt lgkmcnt(0)
    s_barrier
    ds_read_b128 v[16:19], v144 offset:32768
    ds_read_b128 v[20:23], v144 offset:34816
    v_mfma_f32_16x16x32_bf16 v[72:75], v[8:11], v[56:59], v[72:75]
    ds_read_b128 v[24:27], v145 offset:32768
    ds_read_b128 v[28:31], v145 offset:34816
    v_mfma_f32_16x16x32_bf16 v[88:91], v[12:15], v[56:59], v[88:91]
    v_mfma_f32_16x16x32_bf16 v[76:79], v[8:11], v[60:63], v[76:79]
    ds_read_b64_tr_b16 v[56:57], v150 offset:61440
    ds_read_b64_tr_b16 v[58:59], v150 offset:61952
    v_mfma_f32_16x16x32_bf16 v[92:95], v[12:15], v[60:63], v[92:95]
    s_waitcnt lgkmcnt(2)
    v_mfma_f32_16x16x32_bf16 v[112:115], v[96:99], v[16:19], v[112:115]
    ds_read_b64_tr_b16 v[60:61], v151 offset:61440
    ds_read_b64_tr_b16 v[62:63], v151 offset:61952
    v_mfma_f32_16x16x32_bf16 v[112:115], v[100:103], v[20:23], v[112:115]
    ds_read_b64 v[116:117], v156 offset:0
    ds_read_b64 v[118:119], v156 offset:128
    v_mfma_f32_16x16x32_bf16 v[112:115], v[104:107], v[24:27], v[112:115]
    ds_read_b64 v[120:121], v156 offset:256
    ds_read_b64 v[122:123], v156 offset:384
    v_mfma_f32_16x16x32_bf16 v[112:115], v[108:111], v[28:31], v[112:115]
    v_mfma_f32_4x4x4_16b_bf16 v[124:127], v[16:17], v[16:17], v[124:127]
    v_mov_b32 v162, s48
    v_mfma_f32_4x4x4_16b_bf16 v[128:131], v[18:19], v[18:19], v[128:131]
    v_mov_b32 v101, 0
    v_mfma_f32_4x4x4_16b_bf16 v[132:135], v[20:21], v[20:21], v[132:135]
    v_mov_b32 v103, 0
    v_mfma_f32_4x4x4_16b_bf16 v[136:139], v[22:23], v[22:23], v[136:139]
    v_cndmask_b32_e64 v140, 0, v162, vcc
    v_mfma_f32_4x4x4_16b_bf16 v[124:127], v[24:25], v[24:25], v[124:127]
    v_mov_b32 v141, 0
    v_mfma_f32_4x4x4_16b_bf16 v[128:131], v[26:27], v[26:27], v[128:131]
    v_mfma_f32_4x4x4_16b_bf16 v[132:135], v[28:29], v[28:29], v[132:135]
    v_mfma_f32_4x4x4_16b_bf16 v[136:139], v[30:31], v[30:31], v[136:139]
    v_mfma_f32_16x16x32_bf16 v[64:67], v[16:19], v[32:35], v[64:67]
    v_add_f32 v160, v163, v112
    v_mul_f32 v160, 0x3b000000, v160
    v_mfma_f32_16x16x32_bf16 v[80:83], v[20:23], v[32:35], v[80:83]
    v_add_f32 v124, v124, v128
    v_add_f32 v125, v125, v129
    v_mfma_f32_16x16x32_bf16 v[64:67], v[24:27], v[48:51], v[64:67]
    v_add_f32 v126, v126, v130
    v_add_f32 v127, v127, v131
    v_mfma_f32_16x16x32_bf16 v[80:83], v[28:31], v[48:51], v[80:83]
    v_add_f32 v132, v132, v136
    v_add_f32 v133, v133, v137
    v_mfma_f32_16x16x32_bf16 v[68:71], v[16:19], v[36:39], v[68:71]
    v_add_f32 v134, v134, v138
    v_add_f32 v135, v135, v139
    v_mfma_f32_16x16x32_bf16 v[84:87], v[20:23], v[36:39], v[84:87]
    v_cndmask_b32 v124, v124, v125, s[52:53]
    v_cndmask_b32 v126, v126, v127, s[52:53]
    v_mfma_f32_16x16x32_bf16 v[68:71], v[24:27], v[52:55], v[68:71]
    v_cndmask_b32 v132, v132, v133, s[52:53]
    v_cndmask_b32 v134, v134, v135, s[52:53]
    v_mfma_f32_16x16x32_bf16 v[84:87], v[28:31], v[52:55], v[84:87]
    v_cndmask_b32 v124, v124, v126, s[54:55]
    v_cndmask_b32 v132, v132, v134, s[54:55]
    v_mfma_f32_16x16x32_bf16 v[72:75], v[16:19], v[40:43], v[72:75]
    v_cvt_pk_bf16_f32 v96, -v160, -v160
    v_cvt_pk_bf16_f32 v98, -v160, -v160
    v_mfma_f32_16x16x32_bf16 v[88:91], v[20:23], v[40:43], v[88:91]
    v_permlane16_swap_b32 v124, v132
    v_add_f32 v124, v124, v132
    s_waitcnt lgkmcnt(6)
    v_mfma_f32_16x16x32_bf16 v[72:75], v[24:27], v[56:59], v[72:75]
    v_mov_b32 v161, v124
    v_permlane16_swap_b32 v96, v98
    v_mfma_f32_16x16x32_bf16 v[88:91], v[28:31], v[56:59], v[88:91]
    v_cvt_pk_bf16_f32 v149, 0, v160
    v_permlane32_swap_b32 v161, v124
    v_mfma_f32_16x16x32_bf16 v[76:79], v[16:19], v[44:47], v[76:79]
    v_add_f32 v161, v161, v124
    v_mul_f32 v161, 0x3b000000, v161
    v_mfma_f32_16x16x32_bf16 v[92:95], v[20:23], v[44:47], v[92:95]
    v_fma_f32 v161, -v160, v160, v161
    v_max_f32 v161, 0, v161
    s_waitcnt lgkmcnt(4)
    v_mfma_f32_16x16x32_bf16 v[76:79], v[24:27], v[60:63], v[76:79]
    v_cndmask_b32_e64 v96, 0, v96, vcc
    v_cndmask_b32_e64 v98, 0, v98, vcc
    v_mfma_f32_16x16x32_bf16 v[92:95], v[28:31], v[60:63], v[92:95]
    v_mov_b32 v97, v96
    v_mov_b32 v99, v98
    v_cvt_pk_bf16_f32 v161, 0, v161
    v_add_f32 v161, 0x3727c5ac, v161
    s_waitcnt lgkmcnt(0)
    v_mfma_f32_16x16x16_bf16 v[64:67], v[96:97], v[116:117], v[64:67]
    v_cvt_pk_bf16_f32 v161, 0, v161
    v_sqrt_f32 v161, v161
    v_mfma_f32_16x16x16_bf16 v[80:83], v[98:99], v[116:117], v[80:83]
    v_cvt_pk_bf16_f32 v100, v161, 0
    v_cvt_pk_bf16_f32 v102, v161, 0
    v_cvt_pk_bf16_f32 v161, 0, v161
    v_mfma_f32_16x16x16_bf16 v[68:71], v[96:97], v[118:119], v[68:71]
    v_permlane16_swap_b32 v100, v102
    v_mfma_f32_16x16x16_bf16 v[84:87], v[98:99], v[118:119], v[84:87]
    v_rcp_f32 v150, v161
    v_mfma_f32_16x16x16_bf16 v[104:107], v[100:101], v[140:141], 0
    v_mfma_f32_16x16x16_bf16 v[108:111], v[102:103], v[140:141], 0
    v_mfma_f32_16x16x16_bf16 v[72:75], v[96:97], v[120:121], v[72:75]
    s_nop 1
    v_mfma_f32_16x16x16_bf16 v[88:91], v[98:99], v[120:121], v[88:91]
    s_nop 1
    v_mfma_f32_16x16x16_bf16 v[76:79], v[96:97], v[122:123], v[76:79]
    v_rcp_f32 v104, v104
    v_rcp_f32 v105, v105
    v_mfma_f32_16x16x16_bf16 v[92:95], v[98:99], v[122:123], v[92:95]
    v_rcp_f32 v106, v106
    v_rcp_f32 v107, v107
    v_rcp_f32 v108, v108
    v_rcp_f32 v109, v109
    v_rcp_f32 v110, v110
    v_rcp_f32 v111, v111
    v_pk_mul_f32 v[64:65], v[64:65], v[104:105]
    v_pk_mul_f32 v[66:67], v[66:67], v[106:107]
    v_pk_mul_f32 v[80:81], v[80:81], v[108:109]
    v_pk_mul_f32 v[82:83], v[82:83], v[110:111]
    v_cvt_pk_bf16_f32 v0, v64, v65
    v_cvt_pk_bf16_f32 v2, v80, v81
    v_cvt_pk_bf16_f32 v1, v66, v67
    v_cvt_pk_bf16_f32 v3, v82, v83
    v_pk_mul_f32 v[68:69], v[68:69], v[104:105]
    v_pk_mul_f32 v[70:71], v[70:71], v[106:107]
    v_pk_mul_f32 v[84:85], v[84:85], v[108:109]
    v_pk_mul_f32 v[86:87], v[86:87], v[110:111]
    v_permlane16_swap_b32 v0, v2
    v_permlane16_swap_b32 v1, v3
    buffer_store_dwordx4 v[0:3], v167, s[40:43], s50 offen sc1
    v_cvt_pk_bf16_f32 v4, v68, v69
    v_cvt_pk_bf16_f32 v6, v84, v85
    v_cvt_pk_bf16_f32 v5, v70, v71
    v_cvt_pk_bf16_f32 v7, v86, v87
    v_pk_mul_f32 v[72:73], v[72:73], v[104:105]
    v_pk_mul_f32 v[74:75], v[74:75], v[106:107]
    v_pk_mul_f32 v[88:89], v[88:89], v[108:109]
    v_pk_mul_f32 v[90:91], v[90:91], v[110:111]
    v_permlane16_swap_b32 v4, v6
    v_permlane16_swap_b32 v5, v7
    buffer_store_dwordx4 v[4:7], v167, s[40:43], s51 offen sc1
    v_cvt_pk_bf16_f32 v8, v72, v73
    v_cvt_pk_bf16_f32 v10, v88, v89
    v_cvt_pk_bf16_f32 v9, v74, v75
    v_cvt_pk_bf16_f32 v11, v90, v91
    v_pk_mul_f32 v[76:77], v[76:77], v[104:105]
    v_pk_mul_f32 v[78:79], v[78:79], v[106:107]
    v_pk_mul_f32 v[92:93], v[92:93], v[108:109]
    v_pk_mul_f32 v[94:95], v[94:95], v[110:111]
    v_permlane16_swap_b32 v8, v10
    v_permlane16_swap_b32 v9, v11
    buffer_store_dwordx4 v[8:11], v167, s[40:43], s57 offen sc1
    v_cvt_pk_bf16_f32 v12, v76, v77
    v_cvt_pk_bf16_f32 v14, v92, v93
    v_cvt_pk_bf16_f32 v13, v78, v79
    v_cvt_pk_bf16_f32 v15, v94, v95
    v_permlane16_swap_b32 v12, v14
    s_nop 0
    v_permlane16_swap_b32 v13, v15
    buffer_store_dwordx4 v[12:15], v167, s[40:43], s59 offen sc1
    s_setprio 1
    s_barrier
L_a_join:
    v_mov_b32 v24, 157760
    v_mov_b32 v25, 1
    s_mov_b32 exec_hi, 0
    ds_write2_b32 v152, v149, v150 offset1:1
    s_mov_b64 exec, 1
    ds_add_u32 v24, v25 offset:4
    s_mov_b64 exec, -1
    v_mov_b64 v[20:21], 0
    v_mov_b64 v[22:23], 0
    s_cmp_lg_u32 s3, s4
    s_cbranch_scc1 L_a_nokey
    v_and_b32 v160, 31, v166
    s_lshl_b32 s30, s4, 7
    s_lshl_b32 s31, s6, 5
    s_add_u32 s30, s30, s31
    s_sub_u32 s53, 0x7ff, s30
    v_add_f32 v112, v157, v114
    v_fma_f32 v112, -v149, s70, v112
    v_mul_f32 v112, v150, v112
    v_cvt_pk_bf16_f32 v112, 0, v112
    v_ashrrev_i32 v113, 31, v112
    v_or_b32 v113, 0x80000000, v113
    v_xor_b32 v112, v112, v113
    v_and_b32 v112, 0xffff0000, v112
    v_sub_u32 v113, s53, v160
    v_or_b32 v112, v112, v113
    s_nop 1
    v_max_u32_dpp v113, v112, v112 row_ror:8 row_mask:0xf bank_mask:0xf
    s_nop 1
    v_max_u32_dpp v113, v113, v113 row_ror:4 row_mask:0xf bank_mask:0xf
    s_nop 1
    v_max_u32_dpp v113, v113, v113 row_ror:2 row_mask:0xf bank_mask:0xf
    s_nop 1
    v_max_u32_dpp v113, v113, v113 row_ror:1 row_mask:0xf bank_mask:0xf
    s_nop 0
    v_readlane_b32 s50, v113, 0
    v_readlane_b32 s30, v113, 16
    s_nop 0
    s_max_u32 s50, s50, s30
    v_cmp_eq_u32 vcc, s50, v112
    s_lshl_b32 s31, s6, 3
    v_add_u32 v18, s31, v24
    v_cndmask_b32_e64 v112, v112, v20, vcc
    s_nop 1
    v_max_u32_dpp v113, v112, v112 row_ror:8 row_mask:0xf bank_mask:0xf
    s_nop 1
    v_max_u32_dpp v113, v113, v113 row_ror:4 row_mask:0xf bank_mask:0xf
    s_nop 1
    v_max_u32_dpp v113, v113, v113 row_ror:2 row_mask:0xf bank_mask:0xf
    s_nop 1
    v_max_u32_dpp v113, v113, v113 row_ror:1 row_mask:0xf bank_mask:0xf
    s_nop 0
    v_readlane_b32 s51, v113, 0
    v_readlane_b32 s30, v113, 16
    s_nop 0
    s_max_u32 s51, s51, s30
    s_mov_b64 exec, 1
    v_mov_b32 v16, s50
    v_mov_b32 v17, s51
    ds_write_b64 v18, v[16:17] offset:64
L_a_nokey:
    s_mov_b64 exec, 1
    s_waitcnt vmcnt(0)
    ds_add_u32 v24, v25
    s_mov_b64 exec, -1
    v_mov_b64 v[116:117], v[154:155]
    v_mov_b64 v[118:119], v[154:155]
    v_mov_b64 v[120:121], v[154:155]
    v_mov_b64 v[122:123], v[154:155]
    v_mov_b64 v[128:129], v[154:155]
    v_mov_b64 v[130:131], v[154:155]
    v_mov_b64 v[132:133], v[154:155]
    v_mov_b64 v[134:135], v[154:155]
    v_mov_b64 v[140:141], v[154:155]
    v_mov_b64 v[142:143], v[154:155]
    v_mov_b64 v[144:145], v[154:155]
    v_mov_b64 v[146:147], v[154:155]
    v_mov_b64 v[152:153], v[154:155]
    v_mov_b64 v[156:157], v[154:155]
    v_mov_b64 v[158:159], v[154:155]
    v_add_u32 v96, s72, v167
    v_add_u32 v100, s73, v167
    v_add_u32 v104, s74, v167
    v_add_u32 v108, s75, v167
    s_mul_i32 s30, s72, 7
    v_add_u32 v163, s30, v167
    s_mul_i32 s30, s73, 7
    v_add_u32 v164, s30, v167
    s_mul_i32 s30, s74, 7
    v_add_u32 v165, s30, v167
    s_mul_i32 s30, s75, 7
    v_add_u32 v162, s30, v167
    v_mov_b32 v160, 0xdddddddd
    v_lshrrev_b32 v16, 5, v166
    v_bfe_u32 v17, v166, 2, 2
    v_lshl_add_u32 v16, v16, 2, v17
    v_and_b32 v17, 1, v166
    v_lshl_add_u32 v16, v16, 1, v17
    v_bfe_u32 v17, v166, 4, 1
    v_lshl_add_u32 v16, v16, 1, v17
    v_bfe_u32 v17, v166, 1, 1
    v_lshl_add_u32 v16, v16, 1, v17
    s_and_b32 s30, s6, 1
    s_lshl_b32 s30, s30, 15
    s_add_u32 s30, s30, 65536
    v_lshl_add_u32 v166, v16, 3, s30
    s_cmp_eq_u32 s76, 0
    s_cbranch_scc1 L_more0
L_have0:
    s_ff1_i32_b32 s65, s76
    s_bitset0_b32 s76, s65
    s_lshl_b32 s65, s65, 13
    s_add_u32 s65, s65, s61
    s_and_b32 s65, s65, 0x1ffff
    s_add_u32 s65, s65, s64
    buffer_load_dwordx4 v[112:115], v167, s[40:43], s65 offen sc1
    s_mov_b64 exec, s[62:63]
    buffer_load_dwordx4 v[116:119], v167, s[40:43], s65 offen offset:1024 sc1
    buffer_load_dwordx4 v[120:123], v167, s[40:43], s65 offen offset:1280 sc1
    s_mov_b64 exec, -1
    s_setprio 3
    s_waitcnt lgkmcnt(0)
    s_barrier
    ds_read_b128 v[96:99], v96 offset:57344
    ds_read_b128 v[100:103], v100 offset:57344
    ds_read_b128 v[104:107], v104 offset:57344
    ds_read_b128 v[108:111], v108 offset:57344
    v_mfma_f32_32x32x16_bf16 v[32:47], v[20:23], v[20:23], 0
    v_mfma_f32_32x32x16_bf16 v[48:63], v[20:23], v[20:23], 0
    v_mfma_f32_32x32x16_bf16 v[64:79], v[20:23], v[20:23], 0
    v_mfma_f32_32x32x16_bf16 v[80:95], v[20:23], v[20:23], 0
    s_branch L_attn_go
L_bwave:
    v_and_b32 v1, 31, v0
    v_lshrrev_b32 v2, 5, v0
    v_bfe_u32 v3, v0, 1, 3
    v_xor_b32 v3, v3, v2
    s_lshl_b32 s30, s6, 1
    v_xor_b32 v3, s30, v3
    s_lshl_b32 s30, s6, 12
    s_add_u32 s30, s30, 65536
    v_lshl_add_u32 v6, v1, 7, s30
    v_xor_b32 v5, 0, v3
    v_lshl_add_u32 v144, v5, 4, v6
    v_xor_b32 v5, 2, v3
    v_lshl_add_u32 v145, v5, 4, v6
    v_xor_b32 v5, 4, v3
    v_lshl_add_u32 v146, v5, 4, v6
    v_xor_b32 v5, 6, v3
    v_lshl_add_u32 v147, v5, 4, v6
    v_bfe_u32 v3, v0, 2, 2
    v_lshl_add_u32 v3, v2, 3, v3
    v_bfe_u32 v5, v0, 4, 1
    v_lshl_add_u32 v3, v3, 1, v5
    v_and_b32 v5, 1, v0
    v_lshl_add_u32 v3, v3, 1, v5
    v_bfe_u32 v5, v0, 1, 1
    v_lshl_add_u32 v3, v3, 1, v5
    s_lshl_b32 s30, s6, 10
    v_lshl_add_u32 v148, v3, 3, s30
    s_lshr_b32 s30, s6, 1
    s_lshl_b32 s30, s30, 9
    s_and_b32 s31, s6, 1
    s_lshl_b32 s31, s31, 3
    s_add_u32 s30, s30, s31
    s_add_u32 s30, s30, 158976
    v_lshl_add_u32 v149, v1, 4, s30
    s_mov_b32 s52, 0x10100101
    s_mov_b32 s53, 0x10100101
    v_cndmask_b32 v152, 0, v4, s[52:53]
    v_cndmask_b32 v153, 0, v4, s[52:53]
    v_cndmask_b32 v154, 0, v4, s[52:53]
    v_cndmask_b32 v155, 0, v4, s[52:53]
    v_mov_b32 v161, 0
    v_mov_b32 v151, 1
    v_lshlrev_b32 v1, 2, v1
    v_add_u32 v1, 157760, v1
    ds_write_b32 v1, v161
    s_waitcnt lgkmcnt(0)
    s_barrier
    s_barrier
    ds_read_b128 v[0:3], v144 offset:0
    ds_read_b128 v[20:23], v145 offset:0
    ds_read_b128 v[40:43], v146 offset:0
    ds_read_b128 v[60:63], v147 offset:0
    s_waitcnt lgkmcnt(0)
    s_barrier
    ds_read_b128 v[4:7], v144 offset:16384
    ds_read_b128 v[24:27], v145 offset:16384
    ds_read_b128 v[44:47], v146 offset:16384
    ds_read_b128 v[64:67], v147 offset:16384
    s_waitcnt lgkmcnt(0)
    s_barrier
    ds_read_b128 v[8:11], v144 offset:32768
    ds_read_b128 v[28:31], v145 offset:32768
    ds_read_b128 v[48:51], v146 offset:32768
    ds_read_b128 v[68:71], v147 offset:32768
    s_waitcnt lgkmcnt(0)
    s_barrier
    ds_read_b128 v[12:15], v144 offset:49152
    ds_read_b128 v[32:35], v145 offset:49152
    ds_read_b128 v[52:55], v146 offset:49152
    ds_read_b128 v[72:75], v147 offset:49152
    s_waitcnt lgkmcnt(0)
    s_barrier
    v_add_u32 v162, 65536, v144
    ds_read_b128 v[16:19], v162
    v_add_u32 v162, 65536, v145
    ds_read_b128 v[36:39], v162
    v_add_u32 v162, 65536, v146
    ds_read_b128 v[56:59], v162
    v_add_u32 v162, 65536, v147
    ds_read_b128 v[76:79], v162
    s_waitcnt lgkmcnt(0)
    s_barrier
    s_barrier
    s_barrier
    s_waitcnt vmcnt(0)
    v_add_u32 v148, 114688, v148
    v_and_b32 v164, 31, v166
    s_lshl_b32 s30, s6, 5
    v_add_lshl_u32 v164, v164, s30, 3
    v_add_u32 v164, 157952, v164
    s_lshl_b32 s30, s6, 10
    v_add_u32 v165, s30, v167
    v_add_u32 v161, 158976, v167
    v_mov_b32 v160, 157760
    ds_read_b128 v[128:131], v144 offset:0
    ds_read_b128 v[132:135], v144 offset:16384
    ds_read_b128 v[136:139], v144 offset:32768
    s_waitcnt lgkmcnt(0)
    s_setprio 2
    s_barrier
    ds_read_b64_tr_b16 v[80:81], v148 offset:0
    ds_read_b64_tr_b16 v[82:83], v148 offset:256
    ds_read_b64_tr_b16 v[84:85], v148 offset:4096
    ds_read_b64_tr_b16 v[86:87], v148 offset:4352
    ds_read_b64_tr_b16 v[88:89], v148 offset:8192
    ds_read_b64_tr_b16 v[90:91], v148 offset:8448
    ds_read_b64_tr_b16 v[92:93], v148 offset:12288
    ds_read_b64_tr_b16 v[94:95], v148 offset:12544
    ds_read_b64_tr_b16 v[96:97], v148 offset:16384
    ds_read_b64_tr_b16 v[98:99], v148 offset:16640
    s_waitcnt lgkmcnt(8)
    v_mfma_f32_32x32x16_bf16 v[112:127], v[80:83], v[0:3], 0
    ds_read_b64_tr_b16 v[100:101], v148 offset:20480
    ds_read_b64_tr_b16 v[102:103], v148 offset:20736
    v_mfma_f32_16x16x32_bf16 v[140:143], v[152:155], v[80:83], 0
    s_waitcnt lgkmcnt(8)
    v_mfma_f32_32x32x16_bf16 v[112:127], v[84:87], v[4:7], v[112:127]
    ds_read_b64_tr_b16 v[104:105], v148 offset:24576
    ds_read_b64_tr_b16 v[106:107], v148 offset:24832
    v_mfma_f32_16x16x32_bf16 v[140:143], v[152:155], v[84:87], v[140:143]
    s_waitcnt lgkmcnt(8)
    v_mfma_f32_32x32x16_bf16 v[112:127], v[88:91], v[8:11], v[112:127]
    ds_read_b64_tr_b16 v[108:109], v148 offset:28672
    ds_read_b64_tr_b16 v[110:111], v148 offset:28928
    v_mfma_f32_16x16x32_bf16 v[140:143], v[152:155], v[88:91], v[140:143]
    s_waitcnt lgkmcnt(8)
    v_mfma_f32_32x32x16_bf16 v[112:127], v[92:95], v[12:15], v[112:127]
    v_xor_b32 v148, 1024, v148
    ds_read_b64_tr_b16 v[80:81], v148 offset:0
    ds_read_b64_tr_b16 v[82:83], v148 offset:256
    ds_read_b128 v[0:3], v145 offset:0
    v_mfma_f32_16x16x32_bf16 v[140:143], v[152:155], v[92:95], v[140:143]
    s_waitcnt lgkmcnt(9)
    v_mfma_f32_32x32x16_bf16 v[112:127], v[96:99], v[16:19], v[112:127]
    ds_read_b64_tr_b16 v[84:85], v148 offset:4096
    ds_read_b64_tr_b16 v[86:87], v148 offset:4352
    ds_read_b128 v[4:7], v145 offset:16384
    v_mfma_f32_16x16x32_bf16 v[140:143], v[152:155], v[96:99], v[140:143]
    s_waitcnt lgkmcnt(10)
    v_mfma_f32_32x32x16_bf16 v[112:127], v[100:103], v[128:131], v[112:127]
    ds_read_b64_tr_b16 v[88:89], v148 offset:8192
    ds_read_b64_tr_b16 v[90:91], v148 offset:8448
    ds_read_b128 v[8:11], v145 offset:32768
    v_mfma_f32_16x16x32_bf16 v[140:143], v[152:155], v[100:103], v[140:143]
    s_waitcnt lgkmcnt(11)
    v_mfma_f32_32x32x16_bf16 v[112:127], v[104:107], v[132:135], v[112:127]
    ds_read_b64_tr_b16 v[92:93], v148 offset:12288
    ds_read_b64_tr_b16 v[94:95], v148 offset:12544
    v_mfma_f32_16x16x32_bf16 v[140:143], v[152:155], v[104:107], v[140:143]
    s_waitcnt lgkmcnt(11)
    v_mfma_f32_32x32x16_bf16 v[112:127], v[108:111], v[136:139], v[112:127]
    ds_read_b64_tr_b16 v[96:97], v148 offset:16384
    ds_read_b64_tr_b16 v[98:99], v148 offset:16640
    v_mfma_f32_16x16x32_bf16 v[140:143], v[152:155], v[108:111], v[140:143]
    s_waitcnt lgkmcnt(11)
    v_mfma_f32_32x32x16_bf16 v[112:127], v[80:83], v[20:23], v[112:127]
    ds_read_b64_tr_b16 v[100:101], v148 offset:20480
    ds_read_b64_tr_b16 v[102:103], v148 offset:20736
    ds_read_b128 v[128:131], v146 offset:0
    s_waitcnt lgkmcnt(11)
    v_mfma_f32_32x32x16_bf16 v[112:127], v[84:87], v[24:27], v[112:127]
    ds_read_b64_tr_b16 v[104:105], v148 offset:24576
    ds_read_b64_tr_b16 v[106:107], v148 offset:24832
    ds_read_b128 v[132:135], v146 offset:16384
    s_waitcnt lgkmcnt(11)
    v_mfma_f32_32x32x16_bf16 v[112:127], v[88:91], v[28:31], v[112:127]
    ds_read_b64_tr_b16 v[108:109], v148 offset:28672
    ds_read_b64_tr_b16 v[110:111], v148 offset:28928
    ds_read_b128 v[136:139], v146 offset:32768
    v_and_b32 v156, 0xffff0000, v140
    v_sub_f32 v157, v140, v156
    v_and_b32 v158, 0xffff0000, v157
    s_waitcnt lgkmcnt(11)
    v_mfma_f32_32x32x16_bf16 v[112:127], v[92:95], v[32:35], v[112:127]
    v_xor_b32 v148, 3072, v148
    ds_read_b64_tr_b16 v[80:81], v148 offset:0
    ds_read_b64_tr_b16 v[82:83], v148 offset:256
    v_sub_f32 v157, v157, v158
    v_lshrrev_b32 v156, 16, v156
    v_or_b32 v156, v156, v158
    s_waitcnt lgkmcnt(11)
    v_mfma_f32_32x32x16_bf16 v[112:127], v[96:99], v[36:39], v[112:127]
    ds_read_b64_tr_b16 v[84:85], v148 offset:4096
    ds_read_b64_tr_b16 v[86:87], v148 offset:4352
    v_lshrrev_b32 v157, 16, v157
    s_waitcnt lgkmcnt(11)
    v_mfma_f32_32x32x16_bf16 v[112:127], v[100:103], v[0:3], v[112:127]
    ds_read_b64_tr_b16 v[88:89], v148 offset:8192
    ds_read_b64_tr_b16 v[90:91], v148 offset:8448
    ds_write_b64 v149, v[156:157]
    s_mov_b64 exec, 1
    ds_add_u32 v160, v151 offset:4
    s_mov_b64 exec, -1
    s_waitcnt lgkmcnt(12)
    v_mfma_f32_32x32x16_bf16 v[112:127], v[104:107], v[4:7], v[112:127]
    ds_read_b64_tr_b16 v[92:93], v148 offset:12288
    ds_read_b64_tr_b16 v[94:95], v148 offset:12544
    s_waitcnt lgkmcnt(11)
    v_mfma_f32_32x32x16_bf16 v[112:127], v[108:111], v[8:11], v[112:127]
    ds_read_b64_tr_b16 v[96:97], v148 offset:16384
    ds_read_b64_tr_b16 v[98:99], v148 offset:16640
    v_and_b32 v156, 27, v166
    v_cmp_eq_u32 vcc, 16, v156
    s_waitcnt lgkmcnt(10)
    v_mfma_f32_32x32x16_bf16 v[112:127], v[80:83], v[40:43], v[112:127]
    ds_read_b64_tr_b16 v[100:101], v148 offset:20480
    ds_read_b64_tr_b16 v[102:103], v148 offset:20736
    ds_read_b128 v[0:3], v147 offset:0
    s_waitcnt lgkmcnt(11)
    v_mfma_f32_32x32x16_bf16 v[112:127], v[84:87], v[44:47], v[112:127]
    ds_read_b64_tr_b16 v[104:105], v148 offset:24576
    ds_read_b64_tr_b16 v[106:107], v148 offset:24832
    ds_read_b128 v[4:7], v147 offset:16384
    s_waitcnt lgkmcnt(12)
    v_mfma_f32_32x32x16_bf16 v[112:127], v[88:91], v[48:51], v[112:127]
    ds_read_b64_tr_b16 v[108:109], v148 offset:28672
    ds_read_b64_tr_b16 v[110:111], v148 offset:28928
    ds_read_b128 v[8:11], v147 offset:32768
    s_waitcnt lgkmcnt(11)
    v_mfma_f32_32x32x16_bf16 v[112:127], v[92:95], v[52:55], v[112:127]
    v_xor_b32 v148, 1024, v148
    ds_read_b64_tr_b16 v[80:81], v148 offset:0
    ds_read_b64_tr_b16 v[82:83], v148 offset:256
    v_mov_b32 v156, s48
    s_waitcnt lgkmcnt(11)
    v_mfma_f32_32x32x16_bf16 v[112:127], v[96:99], v[56:59], v[112:127]
    ds_read_b64_tr_b16 v[84:85], v148 offset:4096
    ds_read_b64_tr_b16 v[86:87], v148 offset:4352
    v_cndmask_b32_e64 v154, 0, v156, vcc
    v_cndmask_b32_e64 v155, 0, v156, vcc
    s_waitcnt lgkmcnt(11)
    v_mfma_f32_32x32x16_bf16 v[112:127], v[100:103], v[128:131], v[112:127]
    ds_read_b64_tr_b16 v[88:89], v148 offset:8192
    ds_read_b64_tr_b16 v[90:91], v148 offset:8448
    v_mov_b32 v20, 0
    v_mov_b32 v21, 0
    v_mov_b32 v22, 0
    s_waitcnt lgkmcnt(10)
    v_mfma_f32_32x32x16_bf16 v[112:127], v[104:107], v[132:135], v[112:127]
    ds_read_b64_tr_b16 v[92:93], v148 offset:12288
    ds_read_b64_tr_b16 v[94:95], v148 offset:12544
    v_mov_b32 v23, 0
    v_mov_b32 v152, v154
    v_mov_b32 v153, v154
    ds_read_b32 v149, v160 offset:4
    ds_read_b128 v[140:143], v161
    ds_read_b64 v[162:163], v164
    s_waitcnt lgkmcnt(12)
    v_mfma_f32_32x32x16_bf16 v[112:127], v[108:111], v[136:139], v[112:127]
    ds_read_b64_tr_b16 v[96:97], v148 offset:16384
    ds_read_b64_tr_b16 v[98:99], v148 offset:16640
    v_mov_b32 v144, v154
    v_mov_b32 v145, v154
    v_mov_b32 v146, v154
    s_waitcnt lgkmcnt(11)
    v_mfma_f32_32x32x16_bf16 v[112:127], v[80:83], v[60:63], v[112:127]
    ds_read_b64_tr_b16 v[100:101], v148 offset:20480
    ds_read_b64_tr_b16 v[102:103], v148 offset:20736
    v_mov_b32 v128, v154
    v_mov_b32 v129, v154
    v_mov_b32 v130, v154
    s_waitcnt lgkmcnt(11)
    v_mfma_f32_32x32x16_bf16 v[112:127], v[84:87], v[64:67], v[112:127]
    ds_read_b64_tr_b16 v[104:105], v148 offset:24576
    ds_read_b64_tr_b16 v[106:107], v148 offset:24832
    v_mov_b32 v131, v154
    v_mov_b32 v132, v154
    v_mov_b32 v133, v154
    s_waitcnt lgkmcnt(11)
    v_mfma_f32_32x32x16_bf16 v[112:127], v[88:91], v[68:71], v[112:127]
    ds_read_b64_tr_b16 v[108:109], v148 offset:28672
    ds_read_b64_tr_b16 v[110:111], v148 offset:28928
    s_waitcnt lgkmcnt(8)
    v_readfirstlane_b32 s30, v149
    s_mov_b32 s56, 0
    s_cmp_lt_u32 s30, 8
    s_cbranch_scc1 L_b_sq
L_b_sqd:
    v_mfma_f32_32x32x16_bf16 v[112:127], v[92:95], v[72:75], v[112:127]
    v_cvt_pk_bf16_f32 v156, -v162, -v162
    v_cvt_pk_bf16_f32 v157, -v162, -v162
    v_cvt_pk_bf16_f32 v158, -v162, -v162
    v_cvt_pk_bf16_f32 v159, -v162, -v162
    s_waitcnt lgkmcnt(6)
    v_mfma_f32_32x32x16_bf16 v[112:127], v[96:99], v[76:79], v[112:127]
    v_mul_f32 v150, 0x3eb8aa3b, v163
    v_mov_b32 v134, v154
    v_mov_b32 v135, v154
    v_mov_b32 v147, v154
    v_mfma_f32_32x32x16_bf16 v[112:127], v[140:143], v[156:159], v[112:127]
    s_waitcnt lgkmcnt(4)
    v_mfma_f32_32x32x16_bf16 v[112:127], v[100:103], v[0:3], v[112:127]
    v_mov_b32 v140, v154
    v_mov_b32 v141, v154
    v_mov_b32 v142, v154
    v_mov_b32 v143, v154
    v_mov_b32 v156, v154
    s_waitcnt lgkmcnt(2)
    v_mfma_f32_32x32x16_bf16 v[112:127], v[104:107], v[4:7], v[112:127]
    v_mov_b32 v157, v154
    v_mov_b32 v158, v154
    v_mov_b32 v159, v154
    v_add_u32 v96, s72, v167
    v_add_u32 v100, s73, v167
    s_waitcnt lgkmcnt(0)
    v_mfma_f32_32x32x16_bf16 v[112:127], v[108:111], v[8:11], v[112:127]
    v_add_u32 v104, s74, v167
    v_add_u32 v108, s75, v167
    s_mul_i32 s30, s72, 7
    v_add_u32 v163, s30, v167
    s_mul_i32 s30, s73, 7
    v_add_u32 v164, s30, v167
    s_mul_i32 s30, s75, 7
    v_add_u32 v162, s30, v167
    v_mov_b32 v160, 0xdddddddd
    s_nop 2
    v_pk_mul_f32 v[112:113], v[112:113], v[150:151] op_sel_hi:[1,0]
    v_pk_mul_f32 v[114:115], v[114:115], v[150:151] op_sel_hi:[1,0]
    v_pk_mul_f32 v[116:117], v[116:117], v[150:151] op_sel_hi:[1,0]
    v_pk_mul_f32 v[118:119], v[118:119], v[150:151] op_sel_hi:[1,0]
    v_cvt_pk_bf16_f32 v4, v112, v113
    v_cvt_pk_bf16_f32 v5, v114, v115
    v_cvt_pk_bf16_f32 v6, v116, v117
    v_cvt_pk_bf16_f32 v7, v118, v119
    ds_write_b128 v165, v[4:7] offset:57344
    v_pk_mul_f32 v[120:121], v[120:121], v[150:151] op_sel_hi:[1,0]
    v_pk_mul_f32 v[122:123], v[122:123], v[150:151] op_sel_hi:[1,0]
    v_pk_mul_f32 v[124:125], v[124:125], v[150:151] op_sel_hi:[1,0]
    v_pk_mul_f32 v[126:127], v[126:127], v[150:151] op_sel_hi:[1,0]
    v_cvt_pk_bf16_f32 v8, v120, v121
    v_cvt_pk_bf16_f32 v9, v122, v123
    v_cvt_pk_bf16_f32 v10, v124, v125
    v_cvt_pk_bf16_f32 v11, v126, v127
    ds_write_b128 v165, v[8:11] offset:61440
    v_mov_b64 v[116:117], v[154:155]
    v_mov_b64 v[118:119], v[154:155]
    v_mov_b64 v[120:121], v[154:155]
    v_mov_b64 v[122:123], v[154:155]
    s_mul_i32 s30, s74, 7
    v_add_u32 v165, s30, v167
    s_setprio 3
    s_waitcnt lgkmcnt(0)
    s_barrier
    s_cmp_eq_u32 s76, 0
    s_cbranch_scc1 L_more1
L_have1:
    s_ff1_i32_b32 s65, s76
    s_bitset0_b32 s76, s65
    s_lshl_b32 s65, s65, 13
    s_add_u32 s65, s65, s61
    s_and_b32 s65, s65, 0x1ffff
    s_add_u32 s65, s65, s64
    buffer_load_dwordx4 v[112:115], v167, s[40:43], s65 offen sc1
    s_mov_b64 exec, s[62:63]
    buffer_load_dwordx4 v[116:119], v167, s[40:43], s65 offen offset:1024 sc1
    buffer_load_dwordx4 v[120:123], v167, s[40:43], s65 offen offset:1280 sc1
    s_mov_b64 exec, -1
    ds_read_b128 v[96:99], v96 offset:57344
    ds_read_b128 v[100:103], v100 offset:57344
    ds_read_b128 v[104:107], v104 offset:57344
    ds_read_b128 v[108:111], v108 offset:57344
    v_mfma_f32_32x32x16_bf16 v[32:47], v[20:23], v[20:23], 0
    v_mfma_f32_32x32x16_bf16 v[48:63], v[20:23], v[20:23], 0
    v_mfma_f32_32x32x16_bf16 v[64:79], v[20:23], v[20:23], 0
    v_mfma_f32_32x32x16_bf16 v[80:95], v[20:23], v[20:23], 0
L_attn_go:
    s_waitcnt vmcnt(0) lgkmcnt(0)
    v_mfma_f32_32x32x16_bf16 v[0:15], v[112:115], v[96:99], 0
    s_mov_b32 s66, 3
    s_nop 10
    v_exp_f32 v0, v0
    v_exp_f32 v1, v1
    v_exp_f32 v2, v2
    v_exp_f32 v3, v3
    v_exp_f32 v4, v4
    v_mfma_f32_32x32x16_bf16 v[16:31], v[112:115], v[100:103], 0
    v_exp_f32 v5, v5
    v_exp_f32 v6, v6
    v_exp_f32 v7, v7
    v_exp_f32 v8, v8
    v_exp_f32 v9, v9
    v_smfmac_f32_32x32x32_bf16 v[32:47], v[116:119], v[0:7], v160
    s_cmp_eq_u32 s76, 0
    s_cbranch_scc1 L_more2
L_have2:
    s_ff1_i32_b32 s65, s76
    s_bitset0_b32 s76, s65
    s_lshl_b32 s65, s65, 13
    s_add_u32 s65, s65, s61
    s_and_b32 s65, s65, 0x1ffff
    s_add_u32 s65, s65, s64
    buffer_load_dwordx4 v[124:127], v167, s[40:43], s65 offen sc1
    s_mov_b64 exec, s[62:63]
    buffer_load_dwordx4 v[128:131], v167, s[40:43], s65 offen offset:1024 sc1
    buffer_load_dwordx4 v[132:135], v167, s[40:43], s65 offen offset:1280 sc1
    s_mov_b64 exec, -1
    v_exp_f32 v10, v10
    v_exp_f32 v11, v11
    v_exp_f32 v12, v12
    v_exp_f32 v13, v13
    v_exp_f32 v14, v14
    v_exp_f32 v15, v15
    v_exp_f32 v16, v16
    v_exp_f32 v17, v17
    v_smfmac_f32_32x32x32_bf16 v[32:47], v[120:123], v[8:15], v160
    v_exp_f32 v18, v18
    v_exp_f32 v19, v19
    v_exp_f32 v20, v20
    v_mfma_f32_32x32x16_bf16 v[0:15], v[112:115], v[104:107], 0
    v_exp_f32 v21, v21
    v_exp_f32 v22, v22
    v_exp_f32 v23, v23
    v_exp_f32 v24, v24
    v_exp_f32 v25, v25
    v_smfmac_f32_32x32x32_bf16 v[48:63], v[116:119], v[16:23], v160
    v_exp_f32 v26, v26
    v_exp_f32 v27, v27
    v_exp_f32 v28, v28
    v_exp_f32 v29, v29
    v_exp_f32 v30, v30
    v_exp_f32 v31, v31
    v_exp_f32 v0, v0
    v_exp_f32 v1, v1
    v_smfmac_f32_32x32x32_bf16 v[48:63], v[120:123], v[24:31], v160
    s_cmp_eq_u32 s76, 0
    s_cbranch_scc1 L_more3
L_have3:
    s_ff1_i32_b32 s65, s76
    s_bitset0_b32 s76, s65
    s_lshl_b32 s65, s65, 13
    s_add_u32 s65, s65, s61
    s_and_b32 s65, s65, 0x1ffff
    s_add_u32 s65, s65, s64
    buffer_load_dwordx4 v[136:139], v167, s[40:43], s65 offen sc1
    s_mov_b64 exec, s[62:63]
    buffer_load_dwordx4 v[140:143], v167, s[40:43], s65 offen offset:1024 sc1
    buffer_load_dwordx4 v[144:147], v167, s[40:43], s65 offen offset:1280 sc1
    s_mov_b64 exec, -1
    v_exp_f32 v2, v2
    v_exp_f32 v3, v3
    v_exp_f32 v4, v4
    v_mfma_f32_32x32x16_bf16 v[16:31], v[112:115], v[108:111], 0
    v_exp_f32 v5, v5
    v_exp_f32 v6, v6
    v_exp_f32 v7, v7
    v_exp_f32 v8, v8
    v_exp_f32 v9, v9
    v_smfmac_f32_32x32x32_bf16 v[64:79], v[116:119], v[0:7], v160
    v_exp_f32 v10, v10
    v_exp_f32 v11, v11
    v_exp_f32 v12, v12
    v_exp_f32 v13, v13
    v_exp_f32 v14, v14
    s_cmp_eq_u32 s76, 0
    s_cbranch_scc1 L_more4
L_have4:
    s_ff1_i32_b32 s65, s76
    s_bitset0_b32 s76, s65
    s_lshl_b32 s65, s65, 13
    s_add_u32 s65, s65, s61
    s_and_b32 s65, s65, 0x1ffff
    s_add_u32 s65, s65, s64
    buffer_load_dwordx4 v[148:151], v167, s[40:43], s65 offen sc1
    s_mov_b64 exec, s[62:63]
    buffer_load_dwordx4 v[152:155], v167, s[40:43], s65 offen offset:1024 sc1
    buffer_load_dwordx4 v[156:159], v167, s[40:43], s65 offen offset:1280 sc1
    s_mov_b64 exec, -1
    v_exp_f32 v15, v15
    v_exp_f32 v16, v16
    v_exp_f32 v17, v17
    v_smfmac_f32_32x32x32_bf16 v[64:79], v[120:123], v[8:15], v160
    s_waitcnt vmcnt(6)
    v_exp_f32 v18, v18
    v_exp_f32 v19, v19
    v_exp_f32 v20, v20
    v_mfma_f32_32x32x16_bf16 v[0:15], v[124:127], v[96:99], 0
    v_exp_f32 v21, v21
    v_exp_f32 v22, v22
    v_exp_f32 v23, v23
    v_exp_f32 v24, v24
    v_exp_f32 v25, v25
    v_smfmac_f32_32x32x32_bf16 v[80:95], v[116:119], v[16:23], v160
    v_exp_f32 v26, v26
    v_exp_f32 v27, v27
    v_exp_f32 v28, v28
    v_exp_f32 v29, v29
    v_exp_f32 v30, v30
    v_exp_f32 v31, v31
.p2align 3
L_attn:
    v_exp_f32 v0, v0
    v_exp_f32 v1, v1
    v_smfmac_f32_32x32x32_bf16 v[80:95], v[120:123], v[24:31], v160
    s_cmp_eq_u32 s76, 0
    s_cbranch_scc1 L_more5
L_have5:
    v_exp_f32 v2, v2
    v_exp_f32 v3, v3
    v_exp_f32 v4, v4
    v_mfma_f32_32x32x16_bf16 v[16:31], v[124:127], v[100:103], 0
    s_ff1_i32_b32 s65, s76
    v_exp_f32 v5, v5
    v_exp_f32 v6, v6
    v_exp_f32 v7, v7
    v_exp_f32 v8, v8
    v_exp_f32 v9, v9
    v_smfmac_f32_32x32x32_bf16 v[32:47], v[128:131], v[0:7], v160
    s_bitset0_b32 s76, s65
    s_lshl_b32 s65, s65, 13
    v_exp_f32 v10, v10
    v_exp_f32 v11, v11
    v_exp_f32 v12, v12
    v_exp_f32 v13, v13
    v_exp_f32 v14, v14
    v_exp_f32 v15, v15
    v_exp_f32 v16, v16
    v_exp_f32 v17, v17
    v_smfmac_f32_32x32x32_bf16 v[32:47], v[132:135], v[8:15], v160
    s_add_u32 s65, s65, s61
    s_and_b32 s65, s65, 0x1ffff
    v_exp_f32 v18, v18
    v_exp_f32 v19, v19
    v_exp_f32 v20, v20
    v_mfma_f32_32x32x16_bf16 v[0:15], v[124:127], v[104:107], 0
    s_add_u32 s65, s65, s64
    v_exp_f32 v21, v21
    v_exp_f32 v22, v22
    v_exp_f32 v23, v23
    v_exp_f32 v24, v24
    v_exp_f32 v25, v25
    v_smfmac_f32_32x32x32_bf16 v[48:63], v[128:131], v[16:23], v160
    buffer_load_dwordx4 v[112:115], v167, s[40:43], s65 offen sc1
    v_exp_f32 v26, v26
    v_exp_f32 v27, v27
    v_exp_f32 v28, v28
    v_exp_f32 v29, v29
    v_exp_f32 v30, v30
    v_exp_f32 v31, v31
    v_exp_f32 v0, v0
    v_exp_f32 v1, v1
    v_smfmac_f32_32x32x32_bf16 v[48:63], v[132:135], v[24:31], v160
    s_mov_b64 exec, s[62:63]
    buffer_load_dwordx4 v[116:119], v167, s[40:43], s65 offen offset:1024 sc1
    buffer_load_dwordx4 v[120:123], v167, s[40:43], s65 offen offset:1280 sc1
    s_mov_b64 exec, -1
    v_exp_f32 v2, v2
    v_exp_f32 v3, v3
    v_exp_f32 v4, v4
    v_mfma_f32_32x32x16_bf16 v[16:31], v[124:127], v[108:111], 0
    v_exp_f32 v5, v5
    v_exp_f32 v6, v6
    v_exp_f32 v7, v7
    v_exp_f32 v8, v8
    v_exp_f32 v9, v9
    v_smfmac_f32_32x32x32_bf16 v[64:79], v[128:131], v[0:7], v160
    v_exp_f32 v10, v10
    v_exp_f32 v11, v11
    v_exp_f32 v12, v12
    v_exp_f32 v13, v13
    v_exp_f32 v14, v14
    v_exp_f32 v15, v15
    v_exp_f32 v16, v16
    v_exp_f32 v17, v17
    v_smfmac_f32_32x32x32_bf16 v[64:79], v[132:135], v[8:15], v160
    s_waitcnt vmcnt(6)
    v_exp_f32 v18, v18
    v_exp_f32 v19, v19
    v_exp_f32 v20, v20
    v_mfma_f32_32x32x16_bf16 v[0:15], v[136:139], v[96:99], 0
    v_exp_f32 v21, v21
    v_exp_f32 v22, v22
    v_exp_f32 v23, v23
    v_exp_f32 v24, v24
    v_exp_f32 v25, v25
    v_smfmac_f32_32x32x32_bf16 v[80:95], v[128:131], v[16:23], v160
    v_exp_f32 v26, v26
    v_exp_f32 v27, v27
    v_exp_f32 v28, v28
    v_exp_f32 v29, v29
    v_exp_f32 v30, v30
    v_exp_f32 v31, v31
    v_exp_f32 v0, v0
    v_exp_f32 v1, v1
    v_smfmac_f32_32x32x32_bf16 v[80:95], v[132:135], v[24:31], v160
    s_cmp_eq_u32 s76, 0
    s_cbranch_scc1 L_more6
L_have6:
    v_exp_f32 v2, v2
    v_exp_f32 v3, v3
    v_exp_f32 v4, v4
    v_mfma_f32_32x32x16_bf16 v[16:31], v[136:139], v[100:103], 0
    s_ff1_i32_b32 s65, s76
    v_exp_f32 v5, v5
    v_exp_f32 v6, v6
    v_exp_f32 v7, v7
    v_exp_f32 v8, v8
    v_exp_f32 v9, v9
    v_smfmac_f32_32x32x32_bf16 v[32:47], v[140:143], v[0:7], v160
    s_bitset0_b32 s76, s65
    s_lshl_b32 s65, s65, 13
    v_exp_f32 v10, v10
    v_exp_f32 v11, v11
    v_exp_f32 v12, v12
    v_exp_f32 v13, v13
    v_exp_f32 v14, v14
    v_exp_f32 v15, v15
    v_exp_f32 v16, v16
    v_exp_f32 v17, v17
    v_smfmac_f32_32x32x32_bf16 v[32:47], v[144:147], v[8:15], v160
    s_add_u32 s65, s65, s61
    s_and_b32 s65, s65, 0x1ffff
    v_exp_f32 v18, v18
    v_exp_f32 v19, v19
    v_exp_f32 v20, v20
    v_mfma_f32_32x32x16_bf16 v[0:15], v[136:139], v[104:107], 0
    s_add_u32 s65, s65, s64
    v_exp_f32 v21, v21
    v_exp_f32 v22, v22
    v_exp_f32 v23, v23
    v_exp_f32 v24, v24
    v_exp_f32 v25, v25
    v_smfmac_f32_32x32x32_bf16 v[48:63], v[140:143], v[16:23], v160
    buffer_load_dwordx4 v[124:127], v167, s[40:43], s65 offen sc1
    v_exp_f32 v26, v26
    v_exp_f32 v27, v27
    v_exp_f32 v28, v28
    v_exp_f32 v29, v29
    v_exp_f32 v30, v30
    v_exp_f32 v31, v31
    v_exp_f32 v0, v0
    v_exp_f32 v1, v1
    v_smfmac_f32_32x32x32_bf16 v[48:63], v[144:147], v[24:31], v160
    s_mov_b64 exec, s[62:63]
    buffer_load_dwordx4 v[128:131], v167, s[40:43], s65 offen offset:1024 sc1
    buffer_load_dwordx4 v[132:135], v167, s[40:43], s65 offen offset:1280 sc1
    s_mov_b64 exec, -1
    v_exp_f32 v2, v2
    v_exp_f32 v3, v3
    v_exp_f32 v4, v4
    v_mfma_f32_32x32x16_bf16 v[16:31], v[136:139], v[108:111], 0
    v_exp_f32 v5, v5
    v_exp_f32 v6, v6
    v_exp_f32 v7, v7
    v_exp_f32 v8, v8
    v_exp_f32 v9, v9
    v_smfmac_f32_32x32x32_bf16 v[64:79], v[140:143], v[0:7], v160
    v_exp_f32 v10, v10
    v_exp_f32 v11, v11
    v_exp_f32 v12, v12
    v_exp_f32 v13, v13
    v_exp_f32 v14, v14
    v_exp_f32 v15, v15
    v_exp_f32 v16, v16
    v_exp_f32 v17, v17
    v_smfmac_f32_32x32x32_bf16 v[64:79], v[144:147], v[8:15], v160
    s_waitcnt vmcnt(6)
    v_exp_f32 v18, v18
    v_exp_f32 v19, v19
    v_exp_f32 v20, v20
    v_mfma_f32_32x32x16_bf16 v[0:15], v[148:151], v[96:99], 0
    v_exp_f32 v21, v21
    v_exp_f32 v22, v22
    v_exp_f32 v23, v23
    v_exp_f32 v24, v24
    v_exp_f32 v25, v25
    v_smfmac_f32_32x32x32_bf16 v[80:95], v[140:143], v[16:23], v160
    v_exp_f32 v26, v26
    v_exp_f32 v27, v27
    v_exp_f32 v28, v28
    v_exp_f32 v29, v29
    v_exp_f32 v30, v30
    v_exp_f32 v31, v31
    v_exp_f32 v0, v0
    v_exp_f32 v1, v1
    v_smfmac_f32_32x32x32_bf16 v[80:95], v[144:147], v[24:31], v160
    s_cmp_eq_u32 s76, 0
    s_cbranch_scc1 L_more7
L_have7:
    v_exp_f32 v2, v2
    v_exp_f32 v3, v3
    v_exp_f32 v4, v4
    v_mfma_f32_32x32x16_bf16 v[16:31], v[148:151], v[100:103], 0
    s_ff1_i32_b32 s65, s76
    v_exp_f32 v5, v5
    v_exp_f32 v6, v6
    v_exp_f32 v7, v7
    v_exp_f32 v8, v8
    v_exp_f32 v9, v9
    v_smfmac_f32_32x32x32_bf16 v[32:47], v[152:155], v[0:7], v160
    s_bitset0_b32 s76, s65
    s_lshl_b32 s65, s65, 13
    v_exp_f32 v10, v10
    v_exp_f32 v11, v11
    v_exp_f32 v12, v12
    v_exp_f32 v13, v13
    v_exp_f32 v14, v14
    v_exp_f32 v15, v15
    v_exp_f32 v16, v16
    v_exp_f32 v17, v17
    v_smfmac_f32_32x32x32_bf16 v[32:47], v[156:159], v[8:15], v160
    s_add_u32 s65, s65, s61
    s_and_b32 s65, s65, 0x1ffff
    v_exp_f32 v18, v18
    v_exp_f32 v19, v19
    v_exp_f32 v20, v20
    v_mfma_f32_32x32x16_bf16 v[0:15], v[148:151], v[104:107], 0
    s_add_u32 s65, s65, s64
    v_exp_f32 v21, v21
    v_exp_f32 v22, v22
    v_exp_f32 v23, v23
    v_exp_f32 v24, v24
    v_exp_f32 v25, v25
    v_smfmac_f32_32x32x32_bf16 v[48:63], v[152:155], v[16:23], v160
    buffer_load_dwordx4 v[136:139], v167, s[40:43], s65 offen sc1
    v_exp_f32 v26, v26
    v_exp_f32 v27, v27
    v_exp_f32 v28, v28
    v_exp_f32 v29, v29
    v_exp_f32 v30, v30
    v_exp_f32 v31, v31
    v_exp_f32 v0, v0
    v_exp_f32 v1, v1
    v_smfmac_f32_32x32x32_bf16 v[48:63], v[156:159], v[24:31], v160
    s_mov_b64 exec, s[62:63]
    buffer_load_dwordx4 v[140:143], v167, s[40:43], s65 offen offset:1024 sc1
    buffer_load_dwordx4 v[144:147], v167, s[40:43], s65 offen offset:1280 sc1
    s_mov_b64 exec, -1
    v_exp_f32 v2, v2
    v_exp_f32 v3, v3
    v_exp_f32 v4, v4
    v_mfma_f32_32x32x16_bf16 v[16:31], v[148:151], v[108:111], 0
    v_exp_f32 v5, v5
    v_exp_f32 v6, v6
    v_exp_f32 v7, v7
    v_exp_f32 v8, v8
    v_exp_f32 v9, v9
    v_smfmac_f32_32x32x32_bf16 v[64:79], v[152:155], v[0:7], v160
    v_exp_f32 v10, v10
    v_exp_f32 v11, v11
    v_exp_f32 v12, v12
    v_exp_f32 v13, v13
    v_exp_f32 v14, v14
    v_exp_f32 v15, v15
    v_exp_f32 v16, v16
    v_exp_f32 v17, v17
    v_smfmac_f32_32x32x32_bf16 v[64:79], v[156:159], v[8:15], v160
    s_waitcnt vmcnt(6)
    v_exp_f32 v18, v18
    v_exp_f32 v19, v19
    v_exp_f32 v20, v20
    v_mfma_f32_32x32x16_bf16 v[0:15], v[112:115], v[96:99], 0
    v_exp_f32 v21, v21
    v_exp_f32 v22, v22
    v_exp_f32 v23, v23
    v_exp_f32 v24, v24
    v_exp_f32 v25, v25
    v_smfmac_f32_32x32x32_bf16 v[80:95], v[152:155], v[16:23], v160
    v_exp_f32 v26, v26
    v_exp_f32 v27, v27
    v_exp_f32 v28, v28
    v_exp_f32 v29, v29
    v_exp_f32 v30, v30
    v_exp_f32 v31, v31
    v_exp_f32 v0, v0
    v_exp_f32 v1, v1
    v_smfmac_f32_32x32x32_bf16 v[80:95], v[156:159], v[24:31], v160
    s_cmp_eq_u32 s76, 0
    s_cbranch_scc1 L_more8
L_have8:
    v_exp_f32 v2, v2
    v_exp_f32 v3, v3
    v_exp_f32 v4, v4
    v_mfma_f32_32x32x16_bf16 v[16:31], v[112:115], v[100:103], 0
    s_ff1_i32_b32 s65, s76
    v_exp_f32 v5, v5
    v_exp_f32 v6, v6
    v_exp_f32 v7, v7
    v_exp_f32 v8, v8
    v_exp_f32 v9, v9
    v_smfmac_f32_32x32x32_bf16 v[32:47], v[116:119], v[0:7], v160
    s_bitset0_b32 s76, s65
    s_lshl_b32 s65, s65, 13
    v_exp_f32 v10, v10
    v_exp_f32 v11, v11
    v_exp_f32 v12, v12
    v_exp_f32 v13, v13
    v_exp_f32 v14, v14
    v_exp_f32 v15, v15
    v_exp_f32 v16, v16
    v_exp_f32 v17, v17
    v_smfmac_f32_32x32x32_bf16 v[32:47], v[120:123], v[8:15], v160
    s_add_u32 s65, s65, s61
    s_and_b32 s65, s65, 0x1ffff
    v_exp_f32 v18, v18
    v_exp_f32 v19, v19
    v_exp_f32 v20, v20
    v_mfma_f32_32x32x16_bf16 v[0:15], v[112:115], v[104:107], 0
    s_add_u32 s65, s65, s64
    v_exp_f32 v21, v21
    v_exp_f32 v22, v22
    v_exp_f32 v23, v23
    v_exp_f32 v24, v24
    v_exp_f32 v25, v25
    v_smfmac_f32_32x32x32_bf16 v[48:63], v[116:119], v[16:23], v160
    buffer_load_dwordx4 v[148:151], v167, s[40:43], s65 offen sc1
    v_exp_f32 v26, v26
    v_exp_f32 v27, v27
    v_exp_f32 v28, v28
    v_exp_f32 v29, v29
    v_exp_f32 v30, v30
    v_exp_f32 v31, v31
    v_exp_f32 v0, v0
    v_exp_f32 v1, v1
    v_smfmac_f32_32x32x32_bf16 v[48:63], v[120:123], v[24:31], v160
    s_mov_b64 exec, s[62:63]
    buffer_load_dwordx4 v[152:155], v167, s[40:43], s65 offen offset:1024 sc1
    buffer_load_dwordx4 v[156:159], v167, s[40:43], s65 offen offset:1280 sc1
    s_mov_b64 exec, -1
    v_exp_f32 v2, v2
    v_exp_f32 v3, v3
    v_exp_f32 v4, v4
    v_mfma_f32_32x32x16_bf16 v[16:31], v[112:115], v[108:111], 0
    v_exp_f32 v5, v5
    v_exp_f32 v6, v6
    v_exp_f32 v7, v7
    v_exp_f32 v8, v8
    v_exp_f32 v9, v9
    v_smfmac_f32_32x32x32_bf16 v[64:79], v[116:119], v[0:7], v160
    v_exp_f32 v10, v10
    v_exp_f32 v11, v11
    v_exp_f32 v12, v12
    v_exp_f32 v13, v13
    v_exp_f32 v14, v14
    v_exp_f32 v15, v15
    v_exp_f32 v16, v16
    v_exp_f32 v17, v17
    v_smfmac_f32_32x32x32_bf16 v[64:79], v[120:123], v[8:15], v160
    s_waitcnt vmcnt(6)
    v_exp_f32 v18, v18
    v_exp_f32 v19, v19
    v_exp_f32 v20, v20
    v_mfma_f32_32x32x16_bf16 v[0:15], v[124:127], v[96:99], 0
    v_exp_f32 v21, v21
    v_exp_f32 v22, v22
    v_exp_f32 v23, v23
    v_exp_f32 v24, v24
    v_exp_f32 v25, v25
    v_smfmac_f32_32x32x32_bf16 v[80:95], v[116:119], v[16:23], v160
    s_sub_u32 s66, s66, 1
    s_cmp_lg_u32 s66, 0
    v_exp_f32 v26, v26
    v_exp_f32 v27, v27
    v_exp_f32 v28, v28
    v_exp_f32 v29, v29
    v_exp_f32 v30, v30
    v_exp_f32 v31, v31
    s_cbranch_scc1 L_attn
    s_setprio 2
    v_exp_f32 v0, v0
    v_exp_f32 v1, v1
    v_smfmac_f32_32x32x32_bf16 v[80:95], v[120:123], v[24:31], v160
    s_lshl_b32 s30, s4, 2
    s_add_u32 s30, s30, s6
    s_lshl_b32 s30, s30, 15
    s_lshr_b32 s31, s64, 7
    s_add_u32 s30, s30, s31
    s_add_u32 s67, s30, 4194304
    s_lshr_b32 s30, s30, 16
    s_lshl_b32 s30, s30, 8
    s_lshr_b32 s31, s64, 14
    s_add_u32 s30, s30, s31
    s_and_b32 s31, s6, 1
    s_lshl_b32 s31, s31, 2
    s_add_u32 s30, s30, s31
    s_add_u32 s59, s30, 6301696
    s_mov_b32 exec_lo, 0x01010101
    s_mov_b32 exec_hi, 0x01010101
    buffer_load_dword v161, v167, s[40:43], s67 offen sc1
    s_mov_b64 exec, 1
    buffer_load_dword v161, v167, s[40:43], s59 offen sc1
    s_mov_b64 exec, -1
    v_exp_f32 v2, v2
    v_exp_f32 v3, v3
    v_exp_f32 v4, v4
    v_mfma_f32_32x32x16_bf16 v[16:31], v[124:127], v[100:103], 0
    v_exp_f32 v5, v5
    v_exp_f32 v6, v6
    v_exp_f32 v7, v7
    v_exp_f32 v8, v8
    v_exp_f32 v9, v9
    v_smfmac_f32_32x32x32_bf16 v[32:47], v[128:131], v[0:7], v160
    v_exp_f32 v10, v10
    v_exp_f32 v11, v11
    v_exp_f32 v12, v12
    v_exp_f32 v13, v13
    v_exp_f32 v14, v14
    v_exp_f32 v15, v15
    v_exp_f32 v16, v16
    v_exp_f32 v17, v17
    v_smfmac_f32_32x32x32_bf16 v[32:47], v[132:135], v[8:15], v160
    v_exp_f32 v18, v18
    v_exp_f32 v19, v19
    v_exp_f32 v20, v20
    v_mfma_f32_32x32x16_bf16 v[0:15], v[124:127], v[104:107], 0
    v_exp_f32 v21, v21
    v_exp_f32 v22, v22
    v_exp_f32 v23, v23
    v_exp_f32 v24, v24
    v_exp_f32 v25, v25
    v_smfmac_f32_32x32x32_bf16 v[48:63], v[128:131], v[16:23], v160
    v_exp_f32 v26, v26
    v_exp_f32 v27, v27
    v_exp_f32 v28, v28
    v_exp_f32 v29, v29
    v_exp_f32 v30, v30
    v_exp_f32 v31, v31
    v_exp_f32 v0, v0
    v_exp_f32 v1, v1
    v_smfmac_f32_32x32x32_bf16 v[48:63], v[132:135], v[24:31], v160
    v_exp_f32 v2, v2
    v_exp_f32 v3, v3
    v_exp_f32 v4, v4
    v_mfma_f32_32x32x16_bf16 v[16:31], v[124:127], v[108:111], 0
    v_exp_f32 v5, v5
    v_exp_f32 v6, v6
    v_exp_f32 v7, v7
    v_exp_f32 v8, v8
    v_exp_f32 v9, v9
    v_smfmac_f32_32x32x32_bf16 v[64:79], v[128:131], v[0:7], v160
    v_exp_f32 v10, v10
    v_exp_f32 v11, v11
    v_exp_f32 v12, v12
    v_exp_f32 v13, v13
    v_exp_f32 v14, v14
    v_exp_f32 v15, v15
    v_exp_f32 v16, v16
    v_exp_f32 v17, v17
    v_smfmac_f32_32x32x32_bf16 v[64:79], v[132:135], v[8:15], v160
    s_waitcnt vmcnt(5)
    v_exp_f32 v18, v18
    v_exp_f32 v19, v19
    v_exp_f32 v20, v20
    v_mfma_f32_32x32x16_bf16 v[0:15], v[136:139], v[96:99], 0
    v_exp_f32 v21, v21
    v_exp_f32 v22, v22
    v_exp_f32 v23, v23
    v_exp_f32 v24, v24
    v_exp_f32 v25, v25
    v_smfmac_f32_32x32x32_bf16 v[80:95], v[128:131], v[16:23], v160
    v_exp_f32 v26, v26
    v_exp_f32 v27, v27
    v_exp_f32 v28, v28
    v_exp_f32 v29, v29
    v_exp_f32 v30, v30
    v_exp_f32 v31, v31
    v_exp_f32 v0, v0
    v_exp_f32 v1, v1
    v_smfmac_f32_32x32x32_bf16 v[80:95], v[132:135], v[24:31], v160
    v_exp_f32 v2, v2
    v_exp_f32 v3, v3
    v_exp_f32 v4, v4
    v_mfma_f32_32x32x16_bf16 v[16:31], v[136:139], v[100:103], 0
    v_exp_f32 v5, v5
    v_exp_f32 v6, v6
    v_exp_f32 v7, v7
    v_exp_f32 v8, v8
    v_exp_f32 v9, v9
    v_smfmac_f32_32x32x32_bf16 v[32:47], v[140:143], v[0:7], v160
    v_exp_f32 v10, v10
    v_exp_f32 v11, v11
    v_exp_f32 v12, v12
    v_exp_f32 v13, v13
    v_exp_f32 v14, v14
    v_exp_f32 v15, v15
    v_exp_f32 v16, v16
    v_exp_f32 v17, v17
    v_smfmac_f32_32x32x32_bf16 v[32:47], v[144:147], v[8:15], v160
    v_exp_f32 v18, v18
    v_exp_f32 v19, v19
    v_exp_f32 v20, v20
    v_mfma_f32_32x32x16_bf16 v[0:15], v[136:139], v[104:107], 0
    v_exp_f32 v21, v21
    v_exp_f32 v22, v22
    v_exp_f32 v23, v23
    v_exp_f32 v24, v24
    v_exp_f32 v25, v25
    v_smfmac_f32_32x32x32_bf16 v[48:63], v[140:143], v[16:23], v160
    v_exp_f32 v26, v26
    v_exp_f32 v27, v27
    v_exp_f32 v28, v28
    v_exp_f32 v29, v29
    v_exp_f32 v30, v30
    v_exp_f32 v31, v31
    v_exp_f32 v0, v0
    v_exp_f32 v1, v1
    v_smfmac_f32_32x32x32_bf16 v[48:63], v[144:147], v[24:31], v160
    v_exp_f32 v2, v2
    v_exp_f32 v3, v3
    v_exp_f32 v4, v4
    v_mfma_f32_32x32x16_bf16 v[16:31], v[136:139], v[108:111], 0
    v_exp_f32 v5, v5
    v_exp_f32 v6, v6
    v_exp_f32 v7, v7
    v_exp_f32 v8, v8
    v_exp_f32 v9, v9
    v_smfmac_f32_32x32x32_bf16 v[64:79], v[140:143], v[0:7], v160
    v_exp_f32 v10, v10
    v_exp_f32 v11, v11
    v_exp_f32 v12, v12
    v_exp_f32 v13, v13
    v_exp_f32 v14, v14
    v_exp_f32 v15, v15
    v_exp_f32 v16, v16
    v_exp_f32 v17, v17
    v_smfmac_f32_32x32x32_bf16 v[64:79], v[144:147], v[8:15], v160
    s_waitcnt vmcnt(2)
    v_exp_f32 v18, v18
    v_exp_f32 v19, v19
    v_exp_f32 v20, v20
    v_mfma_f32_32x32x16_bf16 v[0:15], v[148:151], v[96:99], 0
    v_exp_f32 v21, v21
    v_exp_f32 v22, v22
    v_exp_f32 v23, v23
    v_exp_f32 v24, v24
    v_exp_f32 v25, v25
    v_smfmac_f32_32x32x32_bf16 v[80:95], v[140:143], v[16:23], v160
    v_exp_f32 v26, v26
    v_exp_f32 v27, v27
    v_exp_f32 v28, v28
    v_exp_f32 v29, v29
    v_exp_f32 v30, v30
    v_exp_f32 v31, v31
    s_setprio 1
    v_exp_f32 v0, v0
    v_exp_f32 v1, v1
    v_smfmac_f32_32x32x32_bf16 v[80:95], v[144:147], v[24:31], v160
    v_exp_f32 v2, v2
    v_exp_f32 v3, v3
    v_exp_f32 v4, v4
    v_mfma_f32_32x32x16_bf16 v[16:31], v[148:151], v[100:103], 0
    v_exp_f32 v5, v5
    v_exp_f32 v6, v6
    v_exp_f32 v7, v7
    v_exp_f32 v8, v8
    v_exp_f32 v9, v9
    v_smfmac_f32_32x32x32_bf16 v[32:47], v[152:155], v[0:7], v160
    v_exp_f32 v10, v10
    v_exp_f32 v11, v11
    v_exp_f32 v12, v12
    v_exp_f32 v13, v13
    v_exp_f32 v14, v14
    v_exp_f32 v15, v15
    v_exp_f32 v16, v16
    v_exp_f32 v17, v17
    v_smfmac_f32_32x32x32_bf16 v[32:47], v[156:159], v[8:15], v160
    v_exp_f32 v18, v18
    v_exp_f32 v19, v19
    v_exp_f32 v20, v20
    v_mfma_f32_32x32x16_bf16 v[0:15], v[148:151], v[104:107], 0
    v_exp_f32 v21, v21
    v_exp_f32 v22, v22
    v_exp_f32 v23, v23
    v_exp_f32 v24, v24
    v_exp_f32 v25, v25
    v_smfmac_f32_32x32x32_bf16 v[48:63], v[152:155], v[16:23], v160
    v_exp_f32 v26, v26
    v_exp_f32 v27, v27
    v_exp_f32 v28, v28
    v_exp_f32 v29, v29
    v_exp_f32 v30, v30
    ds_write_b32 v163, v40 offset:6144
    v_exp_f32 v31, v31
    v_exp_f32 v0, v0
    v_exp_f32 v1, v1
    v_smfmac_f32_32x32x32_bf16 v[48:63], v[156:159], v[24:31], v160
    ds_write_b128 v163, v[32:35] offset:0
    v_exp_f32 v2, v2
    v_exp_f32 v3, v3
    v_exp_f32 v4, v4
    v_mfma_f32_32x32x16_bf16 v[16:31], v[148:151], v[108:111], 0
    v_exp_f32 v5, v5
    v_exp_f32 v6, v6
    v_exp_f32 v7, v7
    v_exp_f32 v8, v8
    v_exp_f32 v9, v9
    v_smfmac_f32_32x32x32_bf16 v[64:79], v[152:155], v[0:7], v160
    ds_write_b128 v163, v[36:39] offset:1024
    v_exp_f32 v10, v10
    v_exp_f32 v11, v11
    v_exp_f32 v12, v12
    v_exp_f32 v13, v13
    v_exp_f32 v14, v14
    ds_write_b32 v164, v56 offset:6148
    v_exp_f32 v15, v15
    v_exp_f32 v16, v16
    v_exp_f32 v17, v17
    v_smfmac_f32_32x32x32_bf16 v[64:79], v[156:159], v[8:15], v160
    ds_write_b128 v164, v[48:51] offset:2048
    s_setprio 0
    v_exp_f32 v18, v18
    v_exp_f32 v19, v19
    v_exp_f32 v20, v20
    v_exp_f32 v21, v21
    v_exp_f32 v22, v22
    v_exp_f32 v23, v23
    v_exp_f32 v24, v24
    v_exp_f32 v25, v25
    v_smfmac_f32_32x32x32_bf16 v[80:95], v[152:155], v[16:23], v160
    ds_write_b128 v164, v[52:55] offset:3072
    v_exp_f32 v26, v26
    v_exp_f32 v27, v27
    v_exp_f32 v28, v28
    ds_write_b128 v165, v[64:67] offset:4096
    v_exp_f32 v29, v29
    v_exp_f32 v30, v30
    ds_write_b128 v165, v[68:71] offset:5120
    ds_write_b32 v165, v72 offset:6152
    v_exp_f32 v31, v31
    s_setprio 2
    s_nop 0
    v_smfmac_f32_32x32x32_bf16 v[80:95], v[156:159], v[24:31], v160
    s_waitcnt lgkmcnt(0)
    s_barrier
    ds_read_b128 v[24:27], v162 offset:6144
    ds_read_b32 v29, v167 offset:6172
    ds_read_b128 v[0:3], v162 offset:0
    ds_read_b128 v[4:7], v162 offset:1024
    ds_read_b128 v[8:11], v162 offset:2048
    ds_read_b128 v[12:15], v162 offset:3072
    ds_read_b128 v[16:19], v162 offset:4096
    ds_read_b128 v[20:23], v162 offset:5120
    s_waitcnt lgkmcnt(6)
    v_add_f32 v24, v24, v25
    v_add_f32 v26, v26, v88
    v_readfirstlane_b32 s70, v29
    v_add_f32 v88, v24, v26
    v_cmp_nle_f32 vcc, 0x2b800000, v88
    v_rcp_f32 v28, v88
    s_mov_b64 s[50:51], vcc
    v_cmp_nge_f32 vcc, 0x53800000, v88
    s_waitcnt lgkmcnt(4)
    v_pk_add_f32 v[80:81], v[80:81], v[0:1]
    v_pk_add_f32 v[82:83], v[82:83], v[2:3]
    v_pk_add_f32 v[84:85], v[84:85], v[4:5]
    v_pk_add_f32 v[86:87], v[86:87], v[6:7]
    s_waitcnt lgkmcnt(2)
    v_pk_add_f32 v[80:81], v[80:81], v[8:9]
    v_pk_add_f32 v[82:83], v[82:83], v[10:11]
    v_pk_add_f32 v[84:85], v[84:85], v[12:13]
    v_pk_add_f32 v[86:87], v[86:87], v[14:15]
    s_waitcnt lgkmcnt(0)
    v_pk_add_f32 v[80:81], v[80:81], v[16:17]
    v_pk_add_f32 v[82:83], v[82:83], v[18:19]
    v_pk_add_f32 v[84:85], v[84:85], v[20:21]
    v_pk_add_f32 v[86:87], v[86:87], v[22:23]
    s_or_b64 s[50:51], s[50:51], vcc
    v_maximum3_f32 v0, |v80|, |v81|, |v82|
    v_maximum3_f32 v1, |v83|, |v84|, |v85|
    v_maximum3_f32 v0, |v86|, |v87|, v0
    v_maximum3_f32 v0, v0, v1, v1
    v_cmp_nge_f32 vcc, 0x7b800000, v0
    s_nop 0
    s_or_b64 s[50:51], s[50:51], vcc
    s_cbranch_scc1 L_slow
L_norm:
    v_pk_mul_f32 v[80:81], v[80:81], v[28:29] op_sel_hi:[1,0]
    v_pk_mul_f32 v[82:83], v[82:83], v[28:29] op_sel_hi:[1,0]
    v_pk_mul_f32 v[84:85], v[84:85], v[28:29] op_sel_hi:[1,0]
    v_pk_mul_f32 v[86:87], v[86:87], v[28:29] op_sel_hi:[1,0]
    v_cvt_pk_bf16_f32 v156, v80, v81
    v_cvt_pk_bf16_f32 v157, v82, v83
    v_cvt_pk_bf16_f32 v158, v84, v85
    v_cvt_pk_bf16_f32 v159, v86, v87
    s_cmp_eq_u32 s70, 0
    s_cbranch_scc1 L_ost_far
    buffer_store_dwordx4 v[156:159], v167, s[40:43], s67 offen
L_ost_done:
    s_cmp_ge_u32 s5, 8
    s_barrier
    s_cbranch_scc1 L_tail_b
    s_and_b32 s50, s6, 1
    s_lshr_b32 s51, s6, 1
    ds_read_b64_tr_b16 v[0:1], v166 offset:0
    ds_read_b64_tr_b16 v[2:3], v166 offset:512
    ds_read_b64_tr_b16 v[4:5], v166 offset:1024
    ds_read_b64_tr_b16 v[6:7], v166 offset:1536
    ds_read_b64_tr_b16 v[8:9], v166 offset:2048
    ds_read_b64_tr_b16 v[10:11], v166 offset:2560
    ds_read_b64_tr_b16 v[12:13], v166 offset:3072
    ds_read_b64_tr_b16 v[14:15], v166 offset:3584
    ds_read_b64_tr_b16 v[16:17], v166 offset:4096
    ds_read_b64_tr_b16 v[18:19], v166 offset:4608
    ds_read_b64_tr_b16 v[20:21], v166 offset:5120
    ds_read_b64_tr_b16 v[22:23], v166 offset:5632
    s_cmp_eq_u32 s70, 0
    s_waitcnt vmcnt(0)
    s_mov_b64 exec, 1
    s_cbranch_scc1 L_of_far_a
    buffer_store_dword v160, v167, s[40:43], s59 offen
    s_branch L_of_done_a
L_of_far_a:
    buffer_store_dword v160, v167, s[40:43], s59 offen sc1
L_of_done_a:
    s_mov_b64 exec, -1
    s_waitcnt lgkmcnt(2)
    ds_read_b64_tr_b16 v[24:25], v166 offset:6144
    ds_read_b64_tr_b16 v[26:27], v166 offset:6656
    ds_read_b64_tr_b16 v[28:29], v166 offset:7168
    ds_read_b64_tr_b16 v[30:31], v166 offset:7680
    ds_read_b64_tr_b16 v[32:33], v166 offset:8192
    ds_read_b64_tr_b16 v[34:35], v166 offset:8704
    ds_read_b64_tr_b16 v[36:37], v166 offset:9216
    ds_read_b64_tr_b16 v[38:39], v166 offset:9728
    ds_read_b64_tr_b16 v[40:41], v166 offset:10240
    ds_read_b64_tr_b16 v[42:43], v166 offset:10752
    ds_read_b64_tr_b16 v[44:45], v166 offset:11264
    ds_read_b64_tr_b16 v[46:47], v166 offset:11776
    s_waitcnt lgkmcnt(2)
    ds_read_b64_tr_b16 v[48:49], v166 offset:12288
    ds_read_b64_tr_b16 v[50:51], v166 offset:12800
    ds_read_b64_tr_b16 v[52:53], v166 offset:13312
    ds_read_b64_tr_b16 v[54:55], v166 offset:13824
    ds_read_b64_tr_b16 v[56:57], v166 offset:14336
    ds_read_b64_tr_b16 v[58:59], v166 offset:14848
    ds_read_b64_tr_b16 v[60:61], v166 offset:15360
    ds_read_b64_tr_b16 v[62:63], v166 offset:15872
    ds_read_b64_tr_b16 v[64:65], v166 offset:16384
    ds_read_b64_tr_b16 v[66:67], v166 offset:16896
    ds_read_b64_tr_b16 v[68:69], v166 offset:17408
    ds_read_b64_tr_b16 v[70:71], v166 offset:17920
    s_waitcnt lgkmcnt(2)
    ds_read_b64_tr_b16 v[72:73], v166 offset:18432
    ds_read_b64_tr_b16 v[74:75], v166 offset:18944
    ds_read_b64_tr_b16 v[76:77], v166 offset:19456
    ds_read_b64_tr_b16 v[78:79], v166 offset:19968
    ds_read_b64_tr_b16 v[80:81], v166 offset:20480
    ds_read_b64_tr_b16 v[82:83], v166 offset:20992
    ds_read_b64_tr_b16 v[84:85], v166 offset:21504
    ds_read_b64_tr_b16 v[86:87], v166 offset:22016
    ds_read_b64_tr_b16 v[88:89], v166 offset:22528
    ds_read_b64_tr_b16 v[90:91], v166 offset:23040
    ds_read_b64_tr_b16 v[92:93], v166 offset:23552
    ds_read_b64_tr_b16 v[94:95], v166 offset:24064
    s_waitcnt lgkmcnt(2)
    ds_read_b64_tr_b16 v[96:97], v166 offset:24576
    ds_read_b64_tr_b16 v[98:99], v166 offset:25088
    ds_read_b64_tr_b16 v[100:101], v166 offset:25600
    ds_read_b64_tr_b16 v[102:103], v166 offset:26112
    ds_read_b64_tr_b16 v[104:105], v166 offset:26624
    ds_read_b64_tr_b16 v[106:107], v166 offset:27136
    ds_read_b64_tr_b16 v[108:109], v166 offset:27648
    ds_read_b64_tr_b16 v[110:111], v166 offset:28160
    ds_read_b64_tr_b16 v[112:113], v166 offset:28672
    ds_read_b64_tr_b16 v[114:115], v166 offset:29184
    ds_read_b64_tr_b16 v[116:117], v166 offset:29696
    ds_read_b64_tr_b16 v[118:119], v166 offset:30208
    s_waitcnt lgkmcnt(2)
    ds_read_b64_tr_b16 v[120:121], v166 offset:30720
    ds_read_b64_tr_b16 v[122:123], v166 offset:31232
    ds_read_b64_tr_b16 v[124:125], v166 offset:31744
    ds_read_b64_tr_b16 v[126:127], v166 offset:32256
    v_bfe_u32 v145, v167, 4, 5
    v_lshrrev_b32 v146, 9, v167
    s_lshl_b32 s30, s50, 2
    v_lshl_add_u32 v146, v146, 1, s30
    v_and_b32 v147, 7, v145
    v_xor_b32 v146, v146, v147
    s_lshl_b32 s30, s51, 12
    s_add_u32 s30, s30, 131072
    v_lshl_add_u32 v145, v145, 7, s30
    v_lshl_add_u32 v162, v146, 4, v145
    v_xor_b32 v163, 16, v162
    s_lshl_b32 s30, s51, 15
    v_add_u32 v166, s30, v167
    s_waitcnt lgkmcnt(0)
    s_barrier
    ds_read_b128 v[144:147], v166 offset:0
    ds_read_b128 v[148:151], v166 offset:1024
    ds_read_b128 v[152:155], v166 offset:2048
    s_waitcnt lgkmcnt(2)
    v_mfma_f32_32x32x16_bf16 v[128:143], v[0:3], v[144:147], 0
    ds_read_b128 v[156:159], v166 offset:3072
    s_waitcnt lgkmcnt(2)
    v_mfma_f32_32x32x16_bf16 v[128:143], v[4:7], v[148:151], v[128:143]
    s_barrier
    ds_read_b128 v[144:147], v166 offset:4096
    s_waitcnt lgkmcnt(2)
    v_mfma_f32_32x32x16_bf16 v[128:143], v[8:11], v[152:155], v[128:143]
    ds_read_b128 v[148:151], v166 offset:5120
    s_waitcnt lgkmcnt(2)
    v_mfma_f32_32x32x16_bf16 v[128:143], v[12:15], v[156:159], v[128:143]
    ds_read_b128 v[152:155], v166 offset:6144
    s_waitcnt lgkmcnt(2)
    v_mfma_f32_32x32x16_bf16 v[128:143], v[16:19], v[144:147], v[128:143]
    ds_read_b128 v[156:159], v166 offset:7168
    s_waitcnt lgkmcnt(2)
    v_mfma_f32_32x32x16_bf16 v[128:143], v[20:23], v[148:151], v[128:143]
    s_barrier
    ds_read_b128 v[144:147], v166 offset:8192
    s_waitcnt lgkmcnt(2)
    v_mfma_f32_32x32x16_bf16 v[128:143], v[24:27], v[152:155], v[128:143]
    ds_read_b128 v[148:151], v166 offset:9216
    s_waitcnt lgkmcnt(2)
    v_mfma_f32_32x32x16_bf16 v[128:143], v[28:31], v[156:159], v[128:143]
    ds_read_b128 v[152:155], v166 offset:10240
    s_waitcnt lgkmcnt(2)
    v_mfma_f32_32x32x16_bf16 v[128:143], v[32:35], v[144:147], v[128:143]
    ds_read_b128 v[156:159], v166 offset:11264
    s_waitcnt lgkmcnt(2)
    v_mfma_f32_32x32x16_bf16 v[128:143], v[36:39], v[148:151], v[128:143]
    s_barrier
    ds_read_b128 v[144:147], v166 offset:12288
    s_waitcnt lgkmcnt(2)
    v_mfma_f32_32x32x16_bf16 v[128:143], v[40:43], v[152:155], v[128:143]
    ds_read_b128 v[148:151], v166 offset:13312
    s_waitcnt lgkmcnt(2)
    v_mfma_f32_32x32x16_bf16 v[128:143], v[44:47], v[156:159], v[128:143]
    ds_read_b128 v[152:155], v166 offset:14336
    s_waitcnt lgkmcnt(2)
    v_mfma_f32_32x32x16_bf16 v[128:143], v[48:51], v[144:147], v[128:143]
    ds_read_b128 v[156:159], v166 offset:15360
    s_waitcnt lgkmcnt(2)
    v_mfma_f32_32x32x16_bf16 v[128:143], v[52:55], v[148:151], v[128:143]
    s_barrier
    ds_read_b128 v[144:147], v166 offset:16384
    s_waitcnt lgkmcnt(2)
    v_mfma_f32_32x32x16_bf16 v[128:143], v[56:59], v[152:155], v[128:143]
    ds_read_b128 v[148:151], v166 offset:17408
    s_waitcnt lgkmcnt(2)
    v_mfma_f32_32x32x16_bf16 v[128:143], v[60:63], v[156:159], v[128:143]
    ds_read_b128 v[152:155], v166 offset:18432
    s_waitcnt lgkmcnt(2)
    v_mfma_f32_32x32x16_bf16 v[128:143], v[64:67], v[144:147], v[128:143]
    ds_read_b128 v[156:159], v166 offset:19456
    s_waitcnt lgkmcnt(2)
    v_mfma_f32_32x32x16_bf16 v[128:143], v[68:71], v[148:151], v[128:143]
    s_barrier
    ds_read_b128 v[144:147], v166 offset:20480
    s_waitcnt lgkmcnt(2)
    v_mfma_f32_32x32x16_bf16 v[128:143], v[72:75], v[152:155], v[128:143]
    ds_read_b128 v[148:151], v166 offset:21504
    s_waitcnt lgkmcnt(2)
    v_mfma_f32_32x32x16_bf16 v[128:143], v[76:79], v[156:159], v[128:143]
    ds_read_b128 v[152:155], v166 offset:22528
    s_waitcnt lgkmcnt(2)
    v_mfma_f32_32x32x16_bf16 v[128:143], v[80:83], v[144:147], v[128:143]
    ds_read_b128 v[156:159], v166 offset:23552
    s_waitcnt lgkmcnt(2)
    v_mfma_f32_32x32x16_bf16 v[128:143], v[84:87], v[148:151], v[128:143]
    s_barrier
    ds_read_b128 v[144:147], v166 offset:24576
    s_waitcnt lgkmcnt(2)
    v_mfma_f32_32x32x16_bf16 v[128:143], v[88:91], v[152:155], v[128:143]
    ds_read_b128 v[148:151], v166 offset:25600
    s_waitcnt lgkmcnt(2)
    v_mfma_f32_32x32x16_bf16 v[128:143], v[92:95], v[156:159], v[128:143]
    ds_read_b128 v[152:155], v166 offset:26624
    s_waitcnt lgkmcnt(2)
    v_mfma_f32_32x32x16_bf16 v[128:143], v[96:99], v[144:147], v[128:143]
    ds_read_b128 v[156:159], v166 offset:27648
    s_waitcnt lgkmcnt(2)
    v_mfma_f32_32x32x16_bf16 v[128:143], v[100:103], v[148:151], v[128:143]
    s_barrier
    ds_read_b128 v[144:147], v166 offset:28672
    s_waitcnt lgkmcnt(2)
    v_mfma_f32_32x32x16_bf16 v[128:143], v[104:107], v[152:155], v[128:143]
    ds_read_b128 v[148:151], v166 offset:29696
    s_waitcnt lgkmcnt(2)
    v_mfma_f32_32x32x16_bf16 v[128:143], v[108:111], v[156:159], v[128:143]
    ds_read_b128 v[152:155], v166 offset:30720
    s_waitcnt lgkmcnt(2)
    v_mfma_f32_32x32x16_bf16 v[128:143], v[112:115], v[144:147], v[128:143]
    ds_read_b128 v[156:159], v166 offset:31744
    s_waitcnt lgkmcnt(2)
    v_mfma_f32_32x32x16_bf16 v[128:143], v[116:119], v[148:151], v[128:143]
    s_waitcnt lgkmcnt(1)
    v_mfma_f32_32x32x16_bf16 v[128:143], v[120:123], v[152:155], v[128:143]
    s_waitcnt lgkmcnt(0)
    v_mfma_f32_32x32x16_bf16 v[128:143], v[124:127], v[156:159], v[128:143]
    s_nop 11
    v_cvt_pk_bf16_f32 v0, v128, v129
    v_cvt_pk_bf16_f32 v1, v130, v131
    v_cvt_pk_bf16_f32 v2, v132, v133
    v_cvt_pk_bf16_f32 v3, v134, v135
    ds_write_b128 v162, v[0:3]
    v_cvt_pk_bf16_f32 v4, v136, v137
    v_cvt_pk_bf16_f32 v5, v138, v139
    v_cvt_pk_bf16_f32 v6, v140, v141
    v_cvt_pk_bf16_f32 v7, v142, v143
    ds_write_b128 v163, v[4:7]
    s_waitcnt lgkmcnt(0)
    s_barrier
    s_endpgm
L_slow:
    v_mov_b32 v162, 0xff800000
    s_mov_b32 s61, 0
L_slow1:
    s_add_u32 s65, s61, s64
    buffer_load_dwordx4 v[112:115], v167, s[40:43], s65 offen sc1
    s_add_u32 s61, s61, 2048
    s_waitcnt vmcnt(0)
    v_mfma_f32_32x32x16_bf16 v[0:15], v[112:115], v[108:111], 0
    s_nop 11
    v_max3_f32 v162, v0, v1, v162
    v_max3_f32 v162, v2, v3, v162
    v_max3_f32 v162, v4, v5, v162
    v_max3_f32 v162, v6, v7, v162
    v_max3_f32 v162, v8, v9, v162
    v_max3_f32 v162, v10, v11, v162
    v_max3_f32 v162, v12, v13, v162
    v_max3_f32 v162, v14, v15, v162
    s_cmp_lt_u32 s61, 0x20000
    s_cbranch_scc1 L_slow1
    v_mov_b32 v163, v162
    s_nop 1
    v_permlane32_swap_b32 v162, v163
    v_max_f32 v162, v162, v163
    v_sub_f32 v16, 0, v162
    v_mov_b32 v80, 0
    v_sub_f32 v17, 0, v162
    v_mov_b32 v81, 0
    v_sub_f32 v18, 0, v162
    v_mov_b32 v82, 0
    v_sub_f32 v19, 0, v162
    v_mov_b32 v83, 0
    v_sub_f32 v20, 0, v162
    v_mov_b32 v84, 0
    v_sub_f32 v21, 0, v162
    v_mov_b32 v85, 0
    v_sub_f32 v22, 0, v162
    v_mov_b32 v86, 0
    v_sub_f32 v23, 0, v162
    v_mov_b32 v87, 0
    v_sub_f32 v24, 0, v162
    v_mov_b32 v88, 0
    v_sub_f32 v25, 0, v162
    v_mov_b32 v89, 0
    v_sub_f32 v26, 0, v162
    v_mov_b32 v90, 0
    v_sub_f32 v27, 0, v162
    v_mov_b32 v91, 0
    v_sub_f32 v28, 0, v162
    v_mov_b32 v92, 0
    v_sub_f32 v29, 0, v162
    v_mov_b32 v93, 0
    v_sub_f32 v30, 0, v162
    v_mov_b32 v94, 0
    v_sub_f32 v31, 0, v162
    v_mov_b32 v95, 0
    s_mov_b32 s61, 0
L_slow2:
    s_add_u32 s65, s61, s64
    buffer_load_dwordx4 v[112:115], v167, s[40:43], s65 offen sc1
    s_mov_b64 exec, s[62:63]
    buffer_load_dwordx4 v[116:119], v167, s[40:43], s65 offen offset:1024 sc1
    buffer_load_dwordx4 v[120:123], v167, s[40:43], s65 offen offset:1280 sc1
    s_mov_b64 exec, -1
    s_add_u32 s61, s61, 2048
    s_waitcnt vmcnt(0)
    v_mfma_f32_32x32x16_bf16 v[0:15], v[112:115], v[108:111], v[16:31]
    s_nop 11
    v_exp_f32 v0, v0
    v_exp_f32 v1, v1
    v_exp_f32 v2, v2
    v_exp_f32 v3, v3
    v_exp_f32 v4, v4
    v_exp_f32 v5, v5
    v_exp_f32 v6, v6
    v_exp_f32 v7, v7
    v_exp_f32 v8, v8
    v_exp_f32 v9, v9
    v_exp_f32 v10, v10
    v_exp_f32 v11, v11
    v_exp_f32 v12, v12
    v_exp_f32 v13, v13
    v_exp_f32 v14, v14
    v_exp_f32 v15, v15
    v_smfmac_f32_32x32x32_bf16 v[80:95], v[116:119], v[0:7], v160
    s_nop 0
    v_smfmac_f32_32x32x32_bf16 v[80:95], v[120:123], v[8:15], v160
    s_cmp_lt_u32 s61, 0x20000
    s_cbranch_scc1 L_slow2
    s_nop 11
    v_rcp_f32 v28, v88
    s_branch L_norm
L_exit:
    s_endpgm
.section .rodata,"a"
.p2align 6
.amdhsa_kernel recurrent_scan__softmax_full_mha__moe_arch_mod__prompt_kernel
  .amdhsa_next_free_vgpr 168
  .amdhsa_next_free_sgpr 102
  .amdhsa_accum_offset 168
  .amdhsa_group_segment_fixed_size 0
  .amdhsa_kernarg_size 88
  .amdhsa_user_sgpr_count 2
  .amdhsa_user_sgpr_kernarg_segment_ptr 1
  .amdhsa_system_sgpr_workgroup_id_x 1
  .amdhsa_float_denorm_mode_32 3
.end_amdhsa_kernel
```
